```python
import torch

def _softmax(x, axis=-1):
    return torch.softmax(x, dim=axis)
def _gelu(x):
    return torch.nn.functional.gelu(x, approximate="tanh")
def _silu(x):
    return torch.nn.functional.silu(x)
def _sigmoid(x):
    return torch.sigmoid(x)
def _layernorm(x, axis=-1, eps=1e-5):
    m = x.mean(dim=axis, keepdim=True)
    v = x.var(dim=axis, keepdim=True, unbiased=False)
    return (x - m) / torch.sqrt(v + eps)
def _scatter_add(tgt, idx, src, axis=0):
    return tgt.clone().index_add_(axis, idx, src)
def _segment_sum(src, seg, n):
    out = torch.zeros((n,) + src.shape[1:], dtype=src.dtype)
    return out.index_add_(0, seg, src)
def _pad(x, pw):
    flat = tuple(v for pair in reversed(pw) for v in pair)
    return torch.nn.functional.pad(x, flat)

kernel_name = 'concat_heads__sliding_block_cached__mha_block_cached__decode'

def setup_inputs():

    _w = (lambda a: (lambda t: t.to(torch.bfloat16) if t.is_floating_point() else t)(torch.as_tensor(a)))
    def _A_setup():
        B, Sq, D = 8, 1, 512
        Hq, Hkv, Sk, Dh = 32, 8, 4096, 128
        assert Hq % Hkv == 0, (Hq, Hkv)
        return {
            "x": _w((lambda *s: torch.randn(*s, dtype=torch.bfloat16) * 0.8)(B, Sq, D)),
            "k_cache": _w((lambda *s: torch.randn(*s, dtype=torch.bfloat16) * 1.6)(B, Hkv, Sk, Dh)),
            "v_cache": _w((lambda *s: torch.randn(*s, dtype=torch.bfloat16) * 0.2)(B, Hkv, Sk, Dh)),
            "wq": _w((lambda *s: torch.randn(*s, dtype=torch.bfloat16) * 1.6)(D, Hq * Dh) * (D ** -0.5)),
            "wo": _w((lambda *s: torch.randn(*s, dtype=torch.bfloat16) * 0.2)(Hq * Dh, D) * ((Hq * Dh) ** -0.5)),
        }
    _A_in = _A_setup()

    def _B_setup():
        B, Sq, D = 8, 1, 512
        H, Sk, Dh = 32, 4096, 128
        return {
            "x": _w((lambda *s: torch.randn(*s, dtype=torch.bfloat16) * 0.8)(B, Sq, D)),
            "k_cache": _w((lambda *s: torch.randn(*s, dtype=torch.bfloat16) * 1.6)(B, H, Sk, Dh)),
            "v_cache": _w((lambda *s: torch.randn(*s, dtype=torch.bfloat16) * 0.2)(B, H, Sk, Dh)),
            "wq": _w((lambda *s: torch.randn(*s, dtype=torch.bfloat16) * 1.6)(D, H * Dh) * (D ** -0.5)),
            "wo": _w((lambda *s: torch.randn(*s, dtype=torch.bfloat16) * 0.2)(H * Dh, D) * ((H * Dh) ** -0.5)),
        }
    _B_in = _B_setup()

    return {
        "A_x": _A_in["x"],
        "A_k_cache": _A_in["k_cache"],
        "A_v_cache": _A_in["v_cache"],
        "A_wq": _A_in["wq"],
        "A_wo": _A_in["wo"],
        "B_x": _B_in["x"],
        "B_k_cache": _B_in["k_cache"],
        "B_v_cache": _B_in["v_cache"],
        "B_wq": _B_in["wq"],
        "B_wo": _B_in["wo"],
    }

def reference(A_x, A_k_cache, A_v_cache, A_wq, A_wo, B_x, B_k_cache, B_v_cache, B_wq, B_wo):
    def _A_ref(x, k_cache, v_cache, wq, wo):
        B, Sq, D = x.shape
        Hq, Dh = 32, 128
        Hkv, Sk = k_cache.shape[1], k_cache.shape[2]
        W = min(4096, max(256, Sk // 4))
        rep = Hq // Hkv
        q = (lambda x, *d: x.permute(*d))((x @ wq).reshape(B, Sq, Hq, Dh), 0, 2, 1, 3)
        k = (lambda x, n, axis: torch.repeat_interleave(x, n, dim=axis))(k_cache[:, :, Sk - W:, :], rep, axis=1)
        v = (lambda x, n, axis: torch.repeat_interleave(x, n, dim=axis))(v_cache[:, :, Sk - W:, :], rep, axis=1)
        scores = torch.einsum("bhqd,bhkd->bhqk", q, k) * (Dh ** -0.5)
        p = _softmax(scores, axis=-1)
        o = torch.einsum("bhqk,bhkd->bhqd", p, v)
        return (lambda x, *d: x.permute(*d))(o, 0, 2, 1, 3).reshape(B, Sq, Hq * Dh) @ wo

    def _B_ref(x, k_cache, v_cache, wq, wo):
        B, Sq, D = x.shape
        H, Dh = 32, 128
        q = (lambda x, *d: x.permute(*d))((x @ wq).reshape(B, Sq, H, Dh), 0, 2, 1, 3)
        scores = torch.einsum("bhqd,bhkd->bhqk", q, k_cache) * (Dh ** -0.5)
        p = _softmax(scores, axis=-1)
        o = torch.einsum("bhqk,bhkd->bhqd", p, v_cache)
        return (lambda x, *d: x.permute(*d))(o, 0, 2, 1, 3).reshape(B, Sq, H * Dh) @ wo

    a = _A_ref(A_x, A_k_cache, A_v_cache, A_wq, A_wo)
    b = _B_ref(B_x, B_k_cache, B_v_cache, B_wq, B_wo)
    return torch.concatenate([a, b], axis=-1)
```

```asm
; @launch grid=(256,1,1) block=(512,1,1) lds=139264
.amdgcn_target "amdgcn-amd-amdhsa--gfx950"
.text
.globl concat_heads__sliding_block_cached__mha_block_cached__decode_kernel
.p2align 8
.type concat_heads__sliding_block_cached__mha_block_cached__decode_kernel,@function
concat_heads__sliding_block_cached__mha_block_cached__decode_kernel:
    s_cmp_ge_u32 s2, 256
    s_cbranch_scc1 L_end
    s_load_dwordx16 s[16:31], s[0:1], 0
    s_load_dwordx8 s[32:39], s[0:1], 64
    s_load_dwordx2 s[40:41], s[0:1], 96
    s_getpc_b64 s[4:5]
L_pc:
    v_lshlrev_b32 v190, 6, v0
    v_min_u32 v190, L_last-L_pc, v190
    global_load_dword v191, v190, s[4:5]
    v_lshrrev_b32 v5, 6, v0
    v_and_b32 v0, 63, v0
    v_readfirstlane_b32 s3, v5
    s_lshr_b32 s6, s2, 3
    s_lshr_b32 s7, s2, 5
    s_xor_b32 s7, s7, s2
    s_and_b32 s7, s7, 7
    s_and_b32 s8, s3, 3
    v_lshrrev_b32 v1, 4, v0
    v_and_b32 v2, 15, v0
    s_mov_b32 s47, 0x20000
    s_mov_b32 s51, 0x20000
    s_cmp_lt_u32 s3, 4
    s_cbranch_scc0 L_stream
L_helper:
    s_and_b32 s42, s8, 1
    s_mov_b32 s46, 0x400000
    s_mov_b32 s50, 8192
    s_cmp_ge_u32 s8, 2
    s_cbranch_scc1 L_hwo
    s_setprio 2
    s_lshr_b32 s64, s2, 3
    s_lshr_b32 s65, s2, 5
    s_xor_b32 s65, s65, s2
    s_and_b32 s65, s65, 7
    s_and_b32 s42, s65, 1
    s_lshr_b32 s65, s65, 1
    s_and_b32 s13, s65, 2
    s_or_b32 s13, s13, s8
    s_lshl_b32 s60, s13, 20
    s_lshl_b32 s10, s64, 8
    s_add_u32 s60, s60, s10
    s_and_b32 s15, s65, 1
    s_lshl_b32 s10, s15, 7
    s_add_u32 s60, s60, s10
    s_mov_b32 s61, 8192
    s_mov_b32 s62, 204800
    v_lshlrev_b32 v63, 16, v1
    v_lshl_add_u32 v63, v2, 3, v63
    v_and_b32 v5, 7, v2
    v_lshlrev_b32 v5, 10, v5
    v_lshl_add_u32 v5, v1, 4, v5
    s_lshl_b32 s10, s13, 8
    v_lshrrev_b32 v6, 3, v2
    v_lshl_add_u32 v5, v6, 7, v5
    s_cmp_eq_u32 s42, 0
    s_waitcnt lgkmcnt(0)
    s_cselect_b32 s44, s22, s32
    s_cselect_b32 s45, s23, s33
    s_cselect_b32 s48, s16, s26
    s_cselect_b32 s49, s17, s27
    s_call_b64 s[90:91], F_wload
    buffer_load_dwordx4 v[16:19], v5, s[48:51], s10 offen offset:0
    buffer_load_dwordx4 v[20:23], v5, s[48:51], s10 offen offset:64
    s_branch L_hw
F_wload:
    buffer_load_dwordx2 v[128:129], v63, s[44:47], s60 offen nt
    s_add_u32 s60, s60, s61
    buffer_load_dwordx2 v[130:131], v63, s[44:47], s60 offen nt
    s_add_u32 s60, s60, s61
    buffer_load_dwordx2 v[132:133], v63, s[44:47], s60 offen nt
    s_add_u32 s60, s60, s61
    buffer_load_dwordx2 v[134:135], v63, s[44:47], s60 offen nt
    s_add_u32 s60, s60, s61
    buffer_load_dwordx2 v[136:137], v63, s[44:47], s60 offen nt
    s_add_u32 s60, s60, s61
    buffer_load_dwordx2 v[138:139], v63, s[44:47], s60 offen nt
    s_add_u32 s60, s60, s61
    buffer_load_dwordx2 v[140:141], v63, s[44:47], s60 offen nt
    s_add_u32 s60, s60, s61
    buffer_load_dwordx2 v[142:143], v63, s[44:47], s60 offen nt
    s_add_u32 s60, s60, s62
    buffer_load_dwordx2 v[144:145], v63, s[44:47], s60 offen nt
    s_add_u32 s60, s60, s61
    buffer_load_dwordx2 v[146:147], v63, s[44:47], s60 offen nt
    s_add_u32 s60, s60, s61
    buffer_load_dwordx2 v[148:149], v63, s[44:47], s60 offen nt
    s_add_u32 s60, s60, s61
    buffer_load_dwordx2 v[150:151], v63, s[44:47], s60 offen nt
    s_add_u32 s60, s60, s61
    buffer_load_dwordx2 v[152:153], v63, s[44:47], s60 offen nt
    s_add_u32 s60, s60, s61
    buffer_load_dwordx2 v[154:155], v63, s[44:47], s60 offen nt
    s_add_u32 s60, s60, s61
    buffer_load_dwordx2 v[156:157], v63, s[44:47], s60 offen nt
    s_add_u32 s60, s60, s61
    buffer_load_dwordx2 v[158:159], v63, s[44:47], s60 offen nt
    s_add_u32 s60, s60, s62
    buffer_load_dwordx2 v[160:161], v63, s[44:47], s60 offen nt
    s_add_u32 s60, s60, s61
    buffer_load_dwordx2 v[162:163], v63, s[44:47], s60 offen nt
    s_add_u32 s60, s60, s61
    buffer_load_dwordx2 v[164:165], v63, s[44:47], s60 offen nt
    s_add_u32 s60, s60, s61
    buffer_load_dwordx2 v[166:167], v63, s[44:47], s60 offen nt
    s_add_u32 s60, s60, s61
    buffer_load_dwordx2 v[168:169], v63, s[44:47], s60 offen nt
    s_add_u32 s60, s60, s61
    buffer_load_dwordx2 v[170:171], v63, s[44:47], s60 offen nt
    s_add_u32 s60, s60, s61
    buffer_load_dwordx2 v[172:173], v63, s[44:47], s60 offen nt
    s_add_u32 s60, s60, s61
    buffer_load_dwordx2 v[174:175], v63, s[44:47], s60 offen nt
    s_add_u32 s60, s60, s62
    buffer_load_dwordx2 v[176:177], v63, s[44:47], s60 offen nt
    s_add_u32 s60, s60, s61
    buffer_load_dwordx2 v[178:179], v63, s[44:47], s60 offen nt
    s_add_u32 s60, s60, s61
    buffer_load_dwordx2 v[180:181], v63, s[44:47], s60 offen nt
    s_add_u32 s60, s60, s61
    buffer_load_dwordx2 v[182:183], v63, s[44:47], s60 offen nt
    s_add_u32 s60, s60, s61
    buffer_load_dwordx2 v[184:185], v63, s[44:47], s60 offen nt
    s_add_u32 s60, s60, s61
    buffer_load_dwordx2 v[186:187], v63, s[44:47], s60 offen nt
    s_add_u32 s60, s60, s61
    buffer_load_dwordx2 v[188:189], v63, s[44:47], s60 offen nt
    s_add_u32 s60, s60, s61
    buffer_load_dwordx2 v[190:191], v63, s[44:47], s60 offen nt
    s_setpc_b64 s[90:91]
L_hwo:
    s_lshr_b32 s64, s2, 3
    s_and_b32 s65, s2, 7
    s_lshl_b32 s60, s64, 17
    s_lshl_b32 s10, s65, 7
    s_add_u32 s60, s60, s10
    s_mov_b32 s61, 1024
    s_mov_b32 s62, 25600
    v_lshlrev_b32 v63, 13, v1
    v_lshl_add_u32 v63, v2, 3, v63
    s_cmp_eq_u32 s42, 0
    s_waitcnt lgkmcnt(0)
    s_cselect_b32 s44, s24, s34
    s_cselect_b32 s45, s25, s35
    v_mov_b32 v5, 0
    ds_write_b32 v5, v5 offset:1544
    s_waitcnt lgkmcnt(0)
L_hw:
    s_load_dword s71, s[40:41], 0
    s_barrier
    s_mov_b32 s9, 0x3e0293ee
    s_mov_b32 s72, 1023
    s_mov_b32 s73, 0x05040100
    s_mov_b32 s74, 0x07060302
    s_mov_b32 s75, 0xffff0000
    v_lshrrev_b32 v57, 5, v0
    v_lshlrev_b32 v56, 4, v0
    v_lshlrev_b32 v55, 3, v0
    s_lshl_b32 s10, s42, 10
    s_lshl_b32 s11, s64, 15
    s_add_u32 s10, s10, s11
    s_lshl_b32 s11, s65, 8
    s_add_u32 s10, s10, s11
    s_lshr_b32 s11, s64, 2
    s_lshl_b32 s11, s11, 12
    s_add_u32 s10, s10, s11
    s_add_u32 s10, s10, 1048576
    v_lshl_add_u32 v58, v2, 4, s10
    v_and_b32 v59, 1, v1
    v_lshlrev_b32 v59, 14, v59
    v_xor_b32 v58, v58, v59
    v_xor_b32 v59, 0x1000, v58
    v_xor_b32 v60, 0x2000, v58
    v_xor_b32 v61, 0x3000, v58
    s_lshl_b32 s68, s7, 5
    s_add_u32 s68, s68, s6
    s_waitcnt lgkmcnt(0)
    s_add_u32 s71, s71, 1
    s_and_b32 s70, s71, s72
    v_mov_b32 v62, s70
    s_getreg_b32 s92, hwreg(HW_REG_XCC_ID, 0, 4)
    s_lshl_b32 s10, s71, 4
    s_or_b32 s92, s92, s10
    s_and_b32 s10, s2, 7
    s_lshl_b32 s10, s10, 9
    s_add_u32 s10, s10, 5308416
    v_lshl_add_u32 v54, v0, 2, s10
    s_cmp_eq_u32 s8, 3
    s_cbranch_scc0 L_hx
    s_lshl_b64 exec, 1, s64
    v_mov_b32 v5, s92
    global_store_dword v54, v5, s[40:41]
    s_mov_b64 exec, -1
L_hx:
    s_cmp_ge_u32 s8, 2
    s_cbranch_scc1 L_hb1
    s_cmp_eq_u32 s8, 1
    s_cbranch_scc0 L_se
    s_lshl_b32 s10, s6, 11
    s_lshl_b32 s11, s7, 8
    s_add_u32 s10, s10, s11
    s_add_u32 s10, s10, 3145728
    v_and_b32 v6, 31, v0
    v_lshl_add_u32 v6, v6, 3, s10
    v_lshl_add_u32 v6, v57, 16, v6
    v_mov_b32 v8, -1
    v_mov_b32 v9, -1
    global_store_dwordx2 v6, v[8:9], s[40:41] sc1 nt
L_se:
    s_call_b64 s[90:91], F_wtr
    s_waitcnt vmcnt(0)
    s_lshl_b32 s10, s8, 11
    v_add_u32 v6, s10, v56
    v_xor_b32 v7, 0x800, v6
    v_mov_b32 v8, 0
    v_mov_b32 v9, 1
    s_call_b64 s[90:91], F_mm
    ds_write_b128 v6, v[32:35] offset:2048
    ds_write_b128 v6, v[36:39] offset:2560
    ds_write_b128 v6, v[40:43] offset:3072
    ds_write_b128 v6, v[44:47] offset:3584
    s_mov_b32 exec_lo, 1
    ds_add_rtn_u32 v5, v8, v9 offset:1544
    s_mov_b32 exec_lo, -1
    ds_read_b128 v[64:67], v7 offset:2048
    ds_read_b128 v[68:71], v7 offset:2560
    ds_read_b128 v[72:75], v7 offset:3072
    ds_read_b128 v[76:79], v7 offset:3584
    s_waitcnt lgkmcnt(0)
    v_readfirstlane_b32 s10, v5
    s_cmp_eq_u32 s10, 0
    s_cbranch_scc1 L_qh
    v_add_f32 v32, v32, v64
    v_add_f32 v33, v33, v65
    v_add_f32 v34, v34, v66
    v_add_f32 v35, v35, v67
    v_add_f32 v36, v36, v68
    v_add_f32 v37, v37, v69
    v_add_f32 v38, v38, v70
    v_add_f32 v39, v39, v71
    v_add_f32 v40, v40, v72
    v_add_f32 v41, v41, v73
    v_add_f32 v42, v42, v74
    v_add_f32 v43, v43, v75
    v_add_f32 v44, v44, v76
    v_add_f32 v45, v45, v77
    v_add_f32 v46, v46, v78
    v_add_f32 v47, v47, v79
    v_bfi_b32 v96, s72, v62, v32
    v_bfi_b32 v100, s72, v62, v33
    v_bfi_b32 v104, s72, v62, v34
    v_bfi_b32 v108, s72, v62, v35
    v_bfi_b32 v97, s72, v62, v36
    v_bfi_b32 v101, s72, v62, v37
    v_bfi_b32 v105, s72, v62, v38
    v_bfi_b32 v109, s72, v62, v39
    v_bfi_b32 v98, s72, v62, v40
    v_bfi_b32 v102, s72, v62, v41
    v_bfi_b32 v106, s72, v62, v42
    v_bfi_b32 v110, s72, v62, v43
    v_bfi_b32 v99, s72, v62, v44
    v_bfi_b32 v103, s72, v62, v45
    v_bfi_b32 v107, s72, v62, v46
    v_bfi_b32 v111, s72, v62, v47
    global_store_dwordx4 v58, v[96:99], s[40:41] sc1
    global_store_dwordx4 v59, v[100:103], s[40:41] sc1
    global_store_dwordx4 v60, v[104:107], s[40:41] sc1
    global_store_dwordx4 v61, v[108:111], s[40:41] sc1
L_qh:
    s_mov_b64 exec, -1
    s_cmp_eq_u32 s8, 1
    s_cbranch_scc0 L_hb1
    s_lshl_b32 s10, s2, 12
    s_add_u32 s10, s10, 1049600
    v_add_u32 v50, s10, v56
    v_add_u32 v51, 0, v55
    s_call_b64 s[90:91], F_getq
    s_branch L_hb1
L_stream:
    s_lshl_b32 s10, s8, 13
    v_and_b32 v6, 3, v2
    v_lshl_add_u32 v6, v1, 2, v6
    v_lshlrev_b32 v3, 4, v6
    v_lshlrev_b32 v4, 4, v2
    s_add_u32 s15, s10, 8192
    s_lshl_b32 s11, s7, 5
    s_add_u32 s11, s11, s6
    s_lshr_b32 s12, s11, 2
    s_lshl_b32 s12, s12, 20
    s_lshl_b32 s11, s11, 20
    s_add_u32 s12, s12, 786432
    s_mov_b32 s55, 0x20000
    s_mov_b32 s59, 0x20000
    s_mov_b32 s46, 0x100000
    s_mov_b32 s50, 0x100000
    s_mov_b32 s54, 0x40000
    s_mov_b32 s58, 0x40000
    s_mov_b32 s13, 0
    s_bitcmp1_b32 s11, 20
    s_cselect_b32 s10, 0x187dab00, 0
    s_xor_b32 s13, s13, s10
    s_bitcmp1_b32 s11, 21
    s_cselect_b32 s10, 0x1422800, 0
    s_xor_b32 s13, s13, s10
    s_bitcmp1_b32 s11, 22
    s_cselect_b32 s10, 0x2f7dd00, 0
    s_xor_b32 s13, s13, s10
    s_bitcmp1_b32 s11, 23
    s_cselect_b32 s10, 0x3e274000, 0
    s_xor_b32 s13, s13, s10
    s_bitcmp1_b32 s11, 24
    s_cselect_b32 s10, 0x315e0000, 0
    s_xor_b32 s13, s13, s10
    s_bitcmp1_b32 s11, 25
    s_cselect_b32 s10, 0x518c000, 0
    s_xor_b32 s13, s13, s10
    s_bitcmp1_b32 s11, 26
    s_cselect_b32 s10, 0x2fb61400, 0
    s_xor_b32 s13, s13, s10
    s_bitcmp1_b32 s11, 27
    s_cselect_b32 s10, 0x8c12700, 0
    s_xor_b32 s13, s13, s10
    s_bitcmp1_b32 s8, 0
    s_cselect_b32 s10, 0x8310000, 0
    s_xor_b32 s13, s13, s10
    s_bitcmp1_b32 s8, 1
    s_cselect_b32 s10, 0x1e78c000, 0
    s_xor_b32 s13, s13, s10
    s_and_b32 s65, s13, 0xfff00
    s_lshr_b32 s13, s13, 20
    s_lshl_b32 s13, s13, 8
    v_bfe_i32 v5, v0, 2, 1
    v_bfe_i32 v7, v0, 3, 1
    v_and_b32 v5, 0x2d100, v5
    v_and_b32 v7, 0x22500, v7
    v_xor_b32 v5, v5, v7
    v_xor_b32 v5, s13, v5
    v_or_b32 v112, v5, v3
    v_bfe_i32 v5, v0, 4, 1
    v_bfe_i32 v7, v0, 5, 1
    v_and_b32 v5, 0x2d100, v5
    v_and_b32 v7, 0x22500, v7
    v_xor_b32 v5, v5, v7
    v_xor_b32 v5, s13, v5
    v_or_b32 v113, v5, v4
    s_movk_i32 s60, 1024
    s_mov_b32 s62, 0x32000
    v_xor_b32 v113, v112, v113
    v_xor_b32 v113, s62, v113
    s_setprio 3
    s_waitcnt lgkmcnt(0)
    s_add_u32 s52, s18, s12
    s_addc_u32 s53, s19, 0
    s_add_u32 s56, s20, s12
    s_addc_u32 s57, s21, 0
    s_add_u32 s44, s28, s11
    s_addc_u32 s45, s29, 0
    s_add_u32 s48, s30, s11
    s_addc_u32 s49, s31, 0
    s_cmp_lg_u32 s8, 0
    s_cbranch_scc1 L_stc
    s_and_b32 s10, s12, 0xff000000
    s_load_dword s68, s[18:19], s10
    s_load_dword s68, s[20:21], s10
    s_and_b32 s10, s11, 0xfe000000
    s_load_dword s68, s[28:29], s10
    s_load_dword s68, s[30:31], s10
    s_load_dword s68, s[24:25], 0
    s_load_dword s68, s[34:35], 0
    s_load_dword s68, s[16:17], 0
    s_load_dword s68, s[26:27], 0
L_stc:
    s_barrier
    s_add_u32 m0, s15, 0
    v_xor_b32 v96, 0x0, v112
    s_waitcnt vmcnt(5)
    buffer_load_dwordx4 v96, s[52:55], 0 offen nt lds
    s_add_u32 m0, m0, s60
    v_xor_b32 v97, 0x2c000, v112
    s_waitcnt vmcnt(5)
    buffer_load_dwordx4 v97, s[52:55], 0 offen nt lds
    s_add_u32 m0, m0, s60
    v_xor_b32 v98, 0xc800, v112
    s_waitcnt vmcnt(5)
    buffer_load_dwordx4 v98, s[52:55], 0 offen nt lds
    s_add_u32 m0, m0, s60
    v_xor_b32 v99, 0x20800, v112
    s_waitcnt vmcnt(5)
    buffer_load_dwordx4 v99, s[52:55], 0 offen nt lds
    s_add_u32 m0, m0, s60
    v_xor_b32 v100, 0xd400, v112
    s_waitcnt vmcnt(5)
    buffer_load_dwordx4 v100, s[52:55], 0 offen nt lds
    s_add_u32 m0, m0, s60
    v_xor_b32 v101, 0x21400, v112
    s_waitcnt vmcnt(5)
    buffer_load_dwordx4 v101, s[52:55], 0 offen nt lds
    s_add_u32 m0, m0, s60
    v_xor_b32 v102, 0x1c00, v112
    s_waitcnt vmcnt(5)
    buffer_load_dwordx4 v102, s[52:55], 0 offen nt lds
    s_add_u32 m0, m0, s60
    v_xor_b32 v103, 0x2dc00, v112
    s_waitcnt vmcnt(5)
    buffer_load_dwordx4 v103, s[52:55], 0 offen nt lds
    s_add_u32 m0, s15, 32768
    v_xor_b32 v96, s62, v96
    s_waitcnt vmcnt(5)
    buffer_load_dwordx4 v96, s[52:55], 0 offen nt lds
    s_mov_b32 s9, 0x3e0293ee
    v_and_b32 v5, 1, v2
    s_add_u32 m0, m0, s60
    v_xor_b32 v97, s62, v97
    s_waitcnt vmcnt(5)
    buffer_load_dwordx4 v97, s[52:55], 0 offen nt lds
    v_cmp_eq_u32 vcc, 1, v5
    v_mov_b32 v7, 0xffff
    v_mov_b32 v5, 0xffff0000
    s_add_u32 m0, m0, s60
    v_xor_b32 v98, s62, v98
    s_waitcnt vmcnt(5)
    buffer_load_dwordx4 v98, s[52:55], 0 offen nt lds
    v_cndmask_b32 v7, v7, v5, vcc
    v_bfe_u32 v5, v2, 1, 2
    v_cmp_eq_u32 vcc, 0, v5
    s_add_u32 m0, m0, s60
    v_xor_b32 v99, s62, v99
    s_waitcnt vmcnt(5)
    buffer_load_dwordx4 v99, s[52:55], 0 offen nt lds
    v_cndmask_b32 v8, 0, v7, vcc
    v_cmp_eq_u32 vcc, 1, v5
    s_nop 1
    v_cndmask_b32 v9, 0, v7, vcc
    v_cmp_eq_u32 vcc, 2, v5
    s_add_u32 m0, m0, s60
    v_xor_b32 v100, s62, v100
    s_waitcnt vmcnt(5)
    buffer_load_dwordx4 v100, s[52:55], 0 offen nt lds
    v_cndmask_b32 v10, 0, v7, vcc
    v_cmp_eq_u32 vcc, 3, v5
    s_nop 1
    v_cndmask_b32 v11, 0, v7, vcc
    s_add_u32 m0, m0, s60
    v_xor_b32 v101, s62, v101
    s_waitcnt vmcnt(5)
    buffer_load_dwordx4 v101, s[52:55], 0 offen nt lds
    v_lshlrev_b32 v59, 4, v6
    s_lshl_b32 s10, s8, 9
    v_lshl_add_u32 v57, v0, 4, s10
    s_add_u32 m0, m0, s60
    v_xor_b32 v102, s62, v102
    s_waitcnt vmcnt(5)
    buffer_load_dwordx4 v102, s[52:55], 0 offen nt lds
    s_lshl_b32 s10, s8, 3
    v_mov_b32 v58, s10
    s_mov_b32 s14, 16
    s_add_u32 m0, m0, s60
    v_xor_b32 v103, s62, v103
    s_waitcnt vmcnt(5)
    buffer_load_dwordx4 v103, s[52:55], 0 offen nt lds
    v_mov_b32 v61, 0
    v_mov_b32 v62, 1
    v_lshlrev_b32 v56, 4, v0
    s_mov_b32 s75, 0xffff0000
    s_add_u32 m0, s15, 65536
    v_xor_b32 v96, v113, v96
    s_waitcnt vmcnt(4)
    buffer_load_dwordx4 v96, s[56:59], 0 offen nt lds
    v_bfe_i32 v5, v0, 2, 1
    v_bfe_i32 v7, v0, 3, 1
    v_and_b32 v5, 0x8c200, v5
    v_and_b32 v7, 0xd400, v7
    v_xor_b32 v5, v5, v7
    v_or_b32 v144, v5, v3
    s_add_u32 m0, m0, s60
    v_xor_b32 v97, v113, v97
    s_waitcnt vmcnt(5)
    buffer_load_dwordx4 v97, s[56:59], 0 offen nt lds
    v_xor_b32 v145, 0xe000, v144
    v_xor_b32 v146, 0x10300, v144
    v_xor_b32 v147, 0x1e300, v144
    s_add_u32 m0, m0, s60
    v_xor_b32 v98, v113, v98
    s_waitcnt vmcnt(4)
    buffer_load_dwordx4 v98, s[56:59], 0 offen nt lds
    v_xor_b32 v148, 0x3e800, v144
    v_xor_b32 v149, 0x30800, v144
    v_xor_b32 v150, 0x2eb00, v144
    s_add_u32 m0, m0, s60
    v_xor_b32 v99, v113, v99
    s_waitcnt vmcnt(5)
    buffer_load_dwordx4 v99, s[56:59], 0 offen nt lds
    v_xor_b32 v151, 0x20b00, v144
    v_bfe_i32 v5, v0, 4, 1
    v_bfe_i32 v7, v0, 5, 1
    v_and_b32 v5, 0x8c200, v5
    v_and_b32 v7, 0xd400, v7
    v_xor_b32 v5, v5, v7
    v_or_b32 v152, v5, v4
    v_xor_b32 v153, 0xe000, v152
    s_add_u32 m0, m0, s60
    v_xor_b32 v100, v113, v100
    s_waitcnt vmcnt(4)
    buffer_load_dwordx4 v100, s[56:59], 0 offen nt lds
    v_xor_b32 v154, 0x10300, v152
    v_xor_b32 v155, 0x1e300, v152
    v_xor_b32 v156, 0x3e800, v152
    s_add_u32 m0, m0, s60
    v_xor_b32 v101, v113, v101
    s_waitcnt vmcnt(5)
    buffer_load_dwordx4 v101, s[56:59], 0 offen nt lds
    v_xor_b32 v157, 0x30800, v152
    v_xor_b32 v158, 0x2eb00, v152
    v_xor_b32 v159, 0x20b00, v152
    s_add_u32 m0, m0, s60
    v_xor_b32 v102, v113, v102
    s_waitcnt vmcnt(4)
    buffer_load_dwordx4 v102, s[56:59], 0 offen nt lds
    v_mov_b32 v160, 0
    v_add_u32 v7, -1, v0
    v_xor_b32 v7, v7, v0
    v_bfe_i32 v5, v7, 0, 1
    v_and_b32 v5, 0x8400, v5
    v_xor_b32 v160, v160, v5
    v_bfe_i32 v5, v7, 1, 1
    v_and_b32 v5, 0x400, v5
    v_xor_b32 v160, v160, v5
    s_add_u32 m0, m0, s60
    v_xor_b32 v103, v113, v103
    s_waitcnt vmcnt(5)
    buffer_load_dwordx4 v103, s[56:59], 0 offen nt lds
    v_bfe_i32 v5, v7, 2, 1
    v_and_b32 v5, 0x20000, v5
    v_xor_b32 v160, v160, v5
    v_bfe_i32 v5, v7, 3, 1
    v_and_b32 v5, 0x40000, v5
    v_xor_b32 v160, v160, v5
    v_bfe_i32 v5, v7, 4, 1
    v_and_b32 v5, 0x80000, v5
    v_xor_b32 v160, v160, v5
    s_add_u32 m0, s15, 98304
    v_xor_b32 v96, s62, v96
    s_waitcnt vmcnt(4)
    buffer_load_dwordx4 v96, s[56:59], 0 offen nt lds
    s_add_u32 m0, m0, s60
    v_xor_b32 v97, s62, v97
    s_waitcnt vmcnt(4)
    buffer_load_dwordx4 v97, s[56:59], 0 offen nt lds
    s_add_u32 m0, m0, s60
    v_xor_b32 v98, s62, v98
    s_waitcnt vmcnt(4)
    buffer_load_dwordx4 v98, s[56:59], 0 offen nt lds
    s_add_u32 m0, m0, s60
    v_xor_b32 v99, s62, v99
    s_waitcnt vmcnt(4)
    buffer_load_dwordx4 v99, s[56:59], 0 offen nt lds
    s_add_u32 m0, m0, s60
    v_xor_b32 v100, s62, v100
    s_waitcnt vmcnt(4)
    buffer_load_dwordx4 v100, s[56:59], 0 offen nt lds
    s_add_u32 m0, m0, s60
    v_xor_b32 v101, s62, v101
    s_waitcnt vmcnt(4)
    buffer_load_dwordx4 v101, s[56:59], 0 offen nt lds
    s_add_u32 m0, m0, s60
    v_xor_b32 v102, s62, v102
    s_waitcnt vmcnt(4)
    buffer_load_dwordx4 v102, s[56:59], 0 offen nt lds
    s_add_u32 m0, m0, s60
    v_xor_b32 v103, s62, v103
    s_waitcnt vmcnt(4)
    buffer_load_dwordx4 v103, s[56:59], 0 offen nt lds
    s_mov_b32 s64, 1
    s_mov_b32 s61, 0x8400
    v_xor_b32 v144, s65, v144
    s_waitcnt vmcnt(4)
    buffer_load_dwordx4 v[64:67], v144, s[44:47], 0 offen nt
    v_xor_b32 v145, s65, v145
    s_waitcnt vmcnt(4)
    buffer_load_dwordx4 v[68:71], v145, s[44:47], 0 offen nt
    v_xor_b32 v146, s65, v146
    s_waitcnt vmcnt(4)
    buffer_load_dwordx4 v[72:75], v146, s[44:47], 0 offen nt
    v_xor_b32 v147, s65, v147
    s_waitcnt vmcnt(4)
    buffer_load_dwordx4 v[76:79], v147, s[44:47], 0 offen nt
    v_xor_b32 v148, s65, v148
    s_waitcnt vmcnt(4)
    buffer_load_dwordx4 v[80:83], v148, s[44:47], 0 offen nt
    v_xor_b32 v149, s65, v149
    s_waitcnt vmcnt(4)
    buffer_load_dwordx4 v[84:87], v149, s[44:47], 0 offen nt
    v_xor_b32 v150, s65, v150
    s_waitcnt vmcnt(4)
    buffer_load_dwordx4 v[88:91], v150, s[44:47], 0 offen nt
    v_xor_b32 v151, s65, v151
    s_waitcnt vmcnt(4)
    buffer_load_dwordx4 v[92:95], v151, s[44:47], 0 offen nt
    s_barrier
    ds_read_b128 v[16:19], v59 offset:0
    s_waitcnt lgkmcnt(0)
    s_mov_b32 s63, 4388
    s_branch L_bk1
.p2align 12
L_bk0:
    v_xor_b32 v144, s61, v144
    s_waitcnt vmcnt(3)
    buffer_load_dwordx4 v[96:99], v144, s[44:47], 0 offen nt
    v_mfma_f32_16x16x32_bf16 v[24:27], v[64:67], v[16:19], 0
    v_add_f32_dpp v141, v31, v28 row_shl:15 row_mask:0xf bank_mask:0xf
    v_add_f32_dpp v35, v34, v35 quad_perm:[2,2,2,2] row_mask:0xf bank_mask:0xf
    v_add_f32_dpp v32, v33, v32 quad_perm:[1,1,1,1] row_mask:0xf bank_mask:0xf
    v_mov_b32_dpp v142, v142 row_shr:1 row_mask:0xf bank_mask:0xf
    v_xor_b32 v145, s61, v145
    s_waitcnt vmcnt(4)
    buffer_load_dwordx4 v[100:103], v145, s[44:47], 0 offen nt
    v_mfma_f32_16x16x32_bf16 v[28:31], v[68:71], v[16:19], 0
    v_add_f32_dpp v142, v35, v32 row_shl:15 row_mask:0xf bank_mask:0xf
    v_add_f32_dpp v39, v38, v39 quad_perm:[2,2,2,2] row_mask:0xf bank_mask:0xf
    v_add_f32_dpp v36, v37, v36 quad_perm:[1,1,1,1] row_mask:0xf bank_mask:0xf
    v_mov_b32_dpp v143, v143 row_shr:1 row_mask:0xf bank_mask:0xf
    v_xor_b32 v146, s61, v146
    s_waitcnt vmcnt(4)
    buffer_load_dwordx4 v[104:107], v146, s[44:47], 0 offen nt
    v_mfma_f32_16x16x32_bf16 v[32:35], v[72:75], v[16:19], 0
    v_add_f32_dpp v27, v26, v27 quad_perm:[2,2,2,2] row_mask:0xf bank_mask:0xf
    v_add_f32_dpp v24, v25, v24 quad_perm:[1,1,1,1] row_mask:0xf bank_mask:0xf
    v_mov_b32_dpp v128, v128 row_shr:1 row_mask:0xf bank_mask:0xf
    v_add_f32_dpp v143, v39, v36 row_shl:15 row_mask:0xf bank_mask:0xf
    v_xor_b32 v147, s61, v147
    s_waitcnt vmcnt(4)
    buffer_load_dwordx4 v[108:111], v147, s[44:47], 0 offen nt
    v_mfma_f32_16x16x32_bf16 v[36:39], v[76:79], v[16:19], 0
    v_add_f32_dpp v128, v27, v24 row_shl:15 row_mask:0xf bank_mask:0xf
    v_add_f32_dpp v31, v30, v31 quad_perm:[2,2,2,2] row_mask:0xf bank_mask:0xf
    v_add_f32_dpp v28, v29, v28 quad_perm:[1,1,1,1] row_mask:0xf bank_mask:0xf
    v_mov_b32_dpp v129, v129 row_shr:1 row_mask:0xf bank_mask:0xf
    v_xor_b32 v148, s61, v148
    s_waitcnt vmcnt(4)
    buffer_load_dwordx4 v[112:115], v148, s[44:47], 0 offen nt
    v_mfma_f32_16x16x32_bf16 v[24:27], v[80:83], v[16:19], 0
    v_add_f32_dpp v129, v31, v28 row_shl:15 row_mask:0xf bank_mask:0xf
    v_add_f32_dpp v35, v34, v35 quad_perm:[2,2,2,2] row_mask:0xf bank_mask:0xf
    v_add_f32_dpp v32, v33, v32 quad_perm:[1,1,1,1] row_mask:0xf bank_mask:0xf
    v_mov_b32_dpp v130, v130 row_shr:1 row_mask:0xf bank_mask:0xf
    v_xor_b32 v149, s61, v149
    s_waitcnt vmcnt(4)
    buffer_load_dwordx4 v[116:119], v149, s[44:47], 0 offen nt
    v_mfma_f32_16x16x32_bf16 v[28:31], v[84:87], v[16:19], 0
    v_add_f32_dpp v130, v35, v32 row_shl:15 row_mask:0xf bank_mask:0xf
    v_add_f32_dpp v39, v38, v39 quad_perm:[2,2,2,2] row_mask:0xf bank_mask:0xf
    v_add_f32_dpp v36, v37, v36 quad_perm:[1,1,1,1] row_mask:0xf bank_mask:0xf
    v_mov_b32_dpp v131, v131 row_shr:1 row_mask:0xf bank_mask:0xf
    v_xor_b32 v150, s61, v150
    s_waitcnt vmcnt(4)
    buffer_load_dwordx4 v[120:123], v150, s[44:47], 0 offen nt
    v_mfma_f32_16x16x32_bf16 v[32:35], v[88:91], v[16:19], 0
    v_add_f32_dpp v131, v39, v36 row_shl:15 row_mask:0xf bank_mask:0xf
    v_add_f32_dpp v27, v26, v27 quad_perm:[2,2,2,2] row_mask:0xf bank_mask:0xf
    v_add_f32_dpp v24, v25, v24 quad_perm:[1,1,1,1] row_mask:0xf bank_mask:0xf
    v_mov_b32_dpp v132, v132 row_shr:1 row_mask:0xf bank_mask:0xf
    v_xor_b32 v151, s61, v151
    s_waitcnt vmcnt(4)
    buffer_load_dwordx4 v[124:127], v151, s[44:47], 0 offen nt
    v_mfma_f32_16x16x32_bf16 v[36:39], v[92:95], v[16:19], 0
    v_add_f32_dpp v132, v27, v24 row_shl:15 row_mask:0xf bank_mask:0xf
    v_add_f32_dpp v31, v30, v31 quad_perm:[2,2,2,2] row_mask:0xf bank_mask:0xf
    v_add_f32_dpp v28, v29, v28 quad_perm:[1,1,1,1] row_mask:0xf bank_mask:0xf
    v_mov_b32_dpp v133, v133 row_shr:1 row_mask:0xf bank_mask:0xf
    s_bitcmp1_b32 s63, s14
    s_cbranch_scc0 L_bkc0
    s_barrier
L_bkc0:
    s_add_u32 s64, s64, 1
    v_readlane_b32 s61, v160, s64
    s_sub_u32 s14, s14, 1
    s_cmp_eq_u32 s14, 0
    s_cbranch_scc1 L_bkend
    v_xor_b32 v144, s61, v144
    s_waitcnt vmcnt(3)
    buffer_load_dwordx4 v[64:67], v144, s[44:47], 0 offen nt
    v_mfma_f32_16x16x32_bf16 v[24:27], v[96:99], v[16:19], 0
    v_add_f32_dpp v133, v31, v28 row_shl:15 row_mask:0xf bank_mask:0xf
    v_add_f32_dpp v35, v34, v35 quad_perm:[2,2,2,2] row_mask:0xf bank_mask:0xf
    v_add_f32_dpp v32, v33, v32 quad_perm:[1,1,1,1] row_mask:0xf bank_mask:0xf
    v_mov_b32_dpp v134, v134 row_shr:1 row_mask:0xf bank_mask:0xf
    v_xor_b32 v145, s61, v145
    s_waitcnt vmcnt(4)
    buffer_load_dwordx4 v[68:71], v145, s[44:47], 0 offen nt
    v_mfma_f32_16x16x32_bf16 v[28:31], v[100:103], v[16:19], 0
    v_add_f32_dpp v134, v35, v32 row_shl:15 row_mask:0xf bank_mask:0xf
    v_add_f32_dpp v39, v38, v39 quad_perm:[2,2,2,2] row_mask:0xf bank_mask:0xf
    v_add_f32_dpp v36, v37, v36 quad_perm:[1,1,1,1] row_mask:0xf bank_mask:0xf
    v_mov_b32_dpp v135, v135 row_shr:1 row_mask:0xf bank_mask:0xf
    v_xor_b32 v146, s61, v146
    s_waitcnt vmcnt(4)
    buffer_load_dwordx4 v[72:75], v146, s[44:47], 0 offen nt
    v_mfma_f32_16x16x32_bf16 v[32:35], v[104:107], v[16:19], 0
    v_add_f32_dpp v27, v26, v27 quad_perm:[2,2,2,2] row_mask:0xf bank_mask:0xf
    v_add_f32_dpp v24, v25, v24 quad_perm:[1,1,1,1] row_mask:0xf bank_mask:0xf
    v_mov_b32_dpp v136, v136 row_shr:1 row_mask:0xf bank_mask:0xf
    v_add_f32_dpp v135, v39, v36 row_shl:15 row_mask:0xf bank_mask:0xf
    v_xor_b32 v147, s61, v147
    s_waitcnt vmcnt(4)
    buffer_load_dwordx4 v[76:79], v147, s[44:47], 0 offen nt
    v_mfma_f32_16x16x32_bf16 v[36:39], v[108:111], v[16:19], 0
    v_add_f32_dpp v136, v27, v24 row_shl:15 row_mask:0xf bank_mask:0xf
    v_add_f32_dpp v31, v30, v31 quad_perm:[2,2,2,2] row_mask:0xf bank_mask:0xf
    v_add_f32_dpp v28, v29, v28 quad_perm:[1,1,1,1] row_mask:0xf bank_mask:0xf
    v_mov_b32_dpp v137, v137 row_shr:1 row_mask:0xf bank_mask:0xf
    v_xor_b32 v148, s61, v148
    s_waitcnt vmcnt(4)
    buffer_load_dwordx4 v[80:83], v148, s[44:47], 0 offen nt
    v_mfma_f32_16x16x32_bf16 v[24:27], v[112:115], v[16:19], 0
    v_add_f32_dpp v137, v31, v28 row_shl:15 row_mask:0xf bank_mask:0xf
    v_add_f32_dpp v35, v34, v35 quad_perm:[2,2,2,2] row_mask:0xf bank_mask:0xf
    v_add_f32_dpp v32, v33, v32 quad_perm:[1,1,1,1] row_mask:0xf bank_mask:0xf
    v_mov_b32_dpp v138, v138 row_shr:1 row_mask:0xf bank_mask:0xf
    v_xor_b32 v149, s61, v149
    s_waitcnt vmcnt(4)
    buffer_load_dwordx4 v[84:87], v149, s[44:47], 0 offen nt
    v_mfma_f32_16x16x32_bf16 v[28:31], v[116:119], v[16:19], 0
    v_add_f32_dpp v138, v35, v32 row_shl:15 row_mask:0xf bank_mask:0xf
    v_add_f32_dpp v39, v38, v39 quad_perm:[2,2,2,2] row_mask:0xf bank_mask:0xf
    v_add_f32_dpp v36, v37, v36 quad_perm:[1,1,1,1] row_mask:0xf bank_mask:0xf
    v_mov_b32_dpp v139, v139 row_shr:1 row_mask:0xf bank_mask:0xf
    v_xor_b32 v150, s61, v150
    s_waitcnt vmcnt(4)
    buffer_load_dwordx4 v[88:91], v150, s[44:47], 0 offen nt
    v_mfma_f32_16x16x32_bf16 v[32:35], v[120:123], v[16:19], 0
    v_add_f32_dpp v139, v39, v36 row_shl:15 row_mask:0xf bank_mask:0xf
    v_add_f32_dpp v27, v26, v27 quad_perm:[2,2,2,2] row_mask:0xf bank_mask:0xf
    v_add_f32_dpp v24, v25, v24 quad_perm:[1,1,1,1] row_mask:0xf bank_mask:0xf
    v_mov_b32_dpp v140, v140 row_shr:1 row_mask:0xf bank_mask:0xf
    v_xor_b32 v151, s61, v151
    s_waitcnt vmcnt(4)
    buffer_load_dwordx4 v[92:95], v151, s[44:47], 0 offen nt
    v_mfma_f32_16x16x32_bf16 v[36:39], v[124:127], v[16:19], 0
    v_add_f32_dpp v140, v27, v24 row_shl:15 row_mask:0xf bank_mask:0xf
    v_add_f32_dpp v31, v30, v31 quad_perm:[2,2,2,2] row_mask:0xf bank_mask:0xf
    v_add_f32_dpp v28, v29, v28 quad_perm:[1,1,1,1] row_mask:0xf bank_mask:0xf
    v_mov_b32_dpp v141, v141 row_shr:1 row_mask:0xf bank_mask:0xf
    ds_read_b32 v60, v61 offset:1536
    s_add_u32 s64, s64, 1
    v_readlane_b32 s61, v160, s64
    s_waitcnt lgkmcnt(0)
    v_readfirstlane_b32 s10, v60
    s_cmp_eq_u32 s10, 0
    s_cbranch_scc1 L_bk0
    s_cmp_eq_u32 s10, 1
    s_cbranch_scc1 L_bk1
    s_cmp_eq_u32 s10, 2
    s_cbranch_scc1 L_bk2
    s_branch L_bk3
L_bk1:
    v_xor_b32 v144, s61, v144
    s_waitcnt vmcnt(4)
    buffer_load_dwordx4 v[96:99], v144, s[44:47], 0 offen nt
    v_mfma_f32_16x16x32_bf16 v[24:27], v[64:67], v[16:19], 0
    v_add_f32_dpp v141, v31, v28 row_shl:15 row_mask:0xf bank_mask:0xf
    v_add_f32_dpp v35, v34, v35 quad_perm:[2,2,2,2] row_mask:0xf bank_mask:0xf
    v_add_f32_dpp v32, v33, v32 quad_perm:[1,1,1,1] row_mask:0xf bank_mask:0xf
    v_mov_b32_dpp v142, v142 row_shr:1 row_mask:0xf bank_mask:0xf
    v_xor_b32 v145, s61, v145
    s_waitcnt vmcnt(5)
    buffer_load_dwordx4 v[100:103], v145, s[44:47], 0 offen nt
    v_mfma_f32_16x16x32_bf16 v[28:31], v[68:71], v[16:19], 0
    v_add_f32_dpp v142, v35, v32 row_shl:15 row_mask:0xf bank_mask:0xf
    v_add_f32_dpp v39, v38, v39 quad_perm:[2,2,2,2] row_mask:0xf bank_mask:0xf
    v_add_f32_dpp v36, v37, v36 quad_perm:[1,1,1,1] row_mask:0xf bank_mask:0xf
    v_mov_b32_dpp v143, v143 row_shr:1 row_mask:0xf bank_mask:0xf
    v_xor_b32 v146, s61, v146
    s_waitcnt vmcnt(4)
    buffer_load_dwordx4 v[104:107], v146, s[44:47], 0 offen nt
    v_mfma_f32_16x16x32_bf16 v[32:35], v[72:75], v[16:19], 0
    v_add_f32_dpp v27, v26, v27 quad_perm:[2,2,2,2] row_mask:0xf bank_mask:0xf
    v_add_f32_dpp v24, v25, v24 quad_perm:[1,1,1,1] row_mask:0xf bank_mask:0xf
    v_mov_b32_dpp v128, v128 row_shr:1 row_mask:0xf bank_mask:0xf
    v_add_f32_dpp v143, v39, v36 row_shl:15 row_mask:0xf bank_mask:0xf
    v_xor_b32 v147, s61, v147
    s_waitcnt vmcnt(5)
    buffer_load_dwordx4 v[108:111], v147, s[44:47], 0 offen nt
    v_mfma_f32_16x16x32_bf16 v[36:39], v[76:79], v[16:19], 0
    v_add_f32_dpp v128, v27, v24 row_shl:15 row_mask:0xf bank_mask:0xf
    v_add_f32_dpp v31, v30, v31 quad_perm:[2,2,2,2] row_mask:0xf bank_mask:0xf
    v_add_f32_dpp v28, v29, v28 quad_perm:[1,1,1,1] row_mask:0xf bank_mask:0xf
    v_mov_b32_dpp v129, v129 row_shr:1 row_mask:0xf bank_mask:0xf
    v_xor_b32 v148, s61, v148
    s_waitcnt vmcnt(4)
    buffer_load_dwordx4 v[112:115], v148, s[44:47], 0 offen nt
    v_mfma_f32_16x16x32_bf16 v[24:27], v[80:83], v[16:19], 0
    v_add_f32_dpp v129, v31, v28 row_shl:15 row_mask:0xf bank_mask:0xf
    v_add_f32_dpp v35, v34, v35 quad_perm:[2,2,2,2] row_mask:0xf bank_mask:0xf
    v_add_f32_dpp v32, v33, v32 quad_perm:[1,1,1,1] row_mask:0xf bank_mask:0xf
    v_mov_b32_dpp v130, v130 row_shr:1 row_mask:0xf bank_mask:0xf
    v_xor_b32 v149, s61, v149
    s_waitcnt vmcnt(5)
    buffer_load_dwordx4 v[116:119], v149, s[44:47], 0 offen nt
    v_mfma_f32_16x16x32_bf16 v[28:31], v[84:87], v[16:19], 0
    v_add_f32_dpp v130, v35, v32 row_shl:15 row_mask:0xf bank_mask:0xf
    v_add_f32_dpp v39, v38, v39 quad_perm:[2,2,2,2] row_mask:0xf bank_mask:0xf
    v_add_f32_dpp v36, v37, v36 quad_perm:[1,1,1,1] row_mask:0xf bank_mask:0xf
    v_mov_b32_dpp v131, v131 row_shr:1 row_mask:0xf bank_mask:0xf
    v_xor_b32 v150, s61, v150
    s_waitcnt vmcnt(4)
    buffer_load_dwordx4 v[120:123], v150, s[44:47], 0 offen nt
    v_mfma_f32_16x16x32_bf16 v[32:35], v[88:91], v[16:19], 0
    v_add_f32_dpp v131, v39, v36 row_shl:15 row_mask:0xf bank_mask:0xf
    v_add_f32_dpp v27, v26, v27 quad_perm:[2,2,2,2] row_mask:0xf bank_mask:0xf
    v_add_f32_dpp v24, v25, v24 quad_perm:[1,1,1,1] row_mask:0xf bank_mask:0xf
    v_mov_b32_dpp v132, v132 row_shr:1 row_mask:0xf bank_mask:0xf
    v_xor_b32 v151, s61, v151
    s_waitcnt vmcnt(5)
    buffer_load_dwordx4 v[124:127], v151, s[44:47], 0 offen nt
    v_mfma_f32_16x16x32_bf16 v[36:39], v[92:95], v[16:19], 0
    v_add_f32_dpp v132, v27, v24 row_shl:15 row_mask:0xf bank_mask:0xf
    v_add_f32_dpp v31, v30, v31 quad_perm:[2,2,2,2] row_mask:0xf bank_mask:0xf
    v_add_f32_dpp v28, v29, v28 quad_perm:[1,1,1,1] row_mask:0xf bank_mask:0xf
    v_mov_b32_dpp v133, v133 row_shr:1 row_mask:0xf bank_mask:0xf
    s_bitcmp1_b32 s63, s14
    s_cbranch_scc0 L_bkc1
    s_barrier
L_bkc1:
    s_add_u32 s64, s64, 1
    v_readlane_b32 s61, v160, s64
    s_sub_u32 s14, s14, 1
    s_cmp_eq_u32 s14, 0
    s_cbranch_scc1 L_bkend
    v_xor_b32 v144, s61, v144
    s_waitcnt vmcnt(4)
    buffer_load_dwordx4 v[64:67], v144, s[44:47], 0 offen nt
    v_mfma_f32_16x16x32_bf16 v[24:27], v[96:99], v[16:19], 0
    v_add_f32_dpp v133, v31, v28 row_shl:15 row_mask:0xf bank_mask:0xf
    v_add_f32_dpp v35, v34, v35 quad_perm:[2,2,2,2] row_mask:0xf bank_mask:0xf
    v_add_f32_dpp v32, v33, v32 quad_perm:[1,1,1,1] row_mask:0xf bank_mask:0xf
    v_mov_b32_dpp v134, v134 row_shr:1 row_mask:0xf bank_mask:0xf
    v_xor_b32 v145, s61, v145
    s_waitcnt vmcnt(5)
    buffer_load_dwordx4 v[68:71], v145, s[44:47], 0 offen nt
    v_mfma_f32_16x16x32_bf16 v[28:31], v[100:103], v[16:19], 0
    v_add_f32_dpp v134, v35, v32 row_shl:15 row_mask:0xf bank_mask:0xf
    v_add_f32_dpp v39, v38, v39 quad_perm:[2,2,2,2] row_mask:0xf bank_mask:0xf
    v_add_f32_dpp v36, v37, v36 quad_perm:[1,1,1,1] row_mask:0xf bank_mask:0xf
    v_mov_b32_dpp v135, v135 row_shr:1 row_mask:0xf bank_mask:0xf
    v_xor_b32 v146, s61, v146
    s_waitcnt vmcnt(4)
    buffer_load_dwordx4 v[72:75], v146, s[44:47], 0 offen nt
    v_mfma_f32_16x16x32_bf16 v[32:35], v[104:107], v[16:19], 0
    v_add_f32_dpp v27, v26, v27 quad_perm:[2,2,2,2] row_mask:0xf bank_mask:0xf
    v_add_f32_dpp v24, v25, v24 quad_perm:[1,1,1,1] row_mask:0xf bank_mask:0xf
    v_mov_b32_dpp v136, v136 row_shr:1 row_mask:0xf bank_mask:0xf
    v_add_f32_dpp v135, v39, v36 row_shl:15 row_mask:0xf bank_mask:0xf
    v_xor_b32 v147, s61, v147
    s_waitcnt vmcnt(5)
    buffer_load_dwordx4 v[76:79], v147, s[44:47], 0 offen nt
    v_mfma_f32_16x16x32_bf16 v[36:39], v[108:111], v[16:19], 0
    v_add_f32_dpp v136, v27, v24 row_shl:15 row_mask:0xf bank_mask:0xf
    v_add_f32_dpp v31, v30, v31 quad_perm:[2,2,2,2] row_mask:0xf bank_mask:0xf
    v_add_f32_dpp v28, v29, v28 quad_perm:[1,1,1,1] row_mask:0xf bank_mask:0xf
    v_mov_b32_dpp v137, v137 row_shr:1 row_mask:0xf bank_mask:0xf
    v_xor_b32 v148, s61, v148
    s_waitcnt vmcnt(4)
    buffer_load_dwordx4 v[80:83], v148, s[44:47], 0 offen nt
    v_mfma_f32_16x16x32_bf16 v[24:27], v[112:115], v[16:19], 0
    v_add_f32_dpp v137, v31, v28 row_shl:15 row_mask:0xf bank_mask:0xf
    v_add_f32_dpp v35, v34, v35 quad_perm:[2,2,2,2] row_mask:0xf bank_mask:0xf
    v_add_f32_dpp v32, v33, v32 quad_perm:[1,1,1,1] row_mask:0xf bank_mask:0xf
    v_mov_b32_dpp v138, v138 row_shr:1 row_mask:0xf bank_mask:0xf
    v_xor_b32 v149, s61, v149
    s_waitcnt vmcnt(5)
    buffer_load_dwordx4 v[84:87], v149, s[44:47], 0 offen nt
    v_mfma_f32_16x16x32_bf16 v[28:31], v[116:119], v[16:19], 0
    v_add_f32_dpp v138, v35, v32 row_shl:15 row_mask:0xf bank_mask:0xf
    v_add_f32_dpp v39, v38, v39 quad_perm:[2,2,2,2] row_mask:0xf bank_mask:0xf
    v_add_f32_dpp v36, v37, v36 quad_perm:[1,1,1,1] row_mask:0xf bank_mask:0xf
    v_mov_b32_dpp v139, v139 row_shr:1 row_mask:0xf bank_mask:0xf
    v_xor_b32 v150, s61, v150
    s_waitcnt vmcnt(4)
    buffer_load_dwordx4 v[88:91], v150, s[44:47], 0 offen nt
    v_mfma_f32_16x16x32_bf16 v[32:35], v[120:123], v[16:19], 0
    v_add_f32_dpp v139, v39, v36 row_shl:15 row_mask:0xf bank_mask:0xf
    v_add_f32_dpp v27, v26, v27 quad_perm:[2,2,2,2] row_mask:0xf bank_mask:0xf
    v_add_f32_dpp v24, v25, v24 quad_perm:[1,1,1,1] row_mask:0xf bank_mask:0xf
    v_mov_b32_dpp v140, v140 row_shr:1 row_mask:0xf bank_mask:0xf
    v_xor_b32 v151, s61, v151
    s_waitcnt vmcnt(5)
    buffer_load_dwordx4 v[92:95], v151, s[44:47], 0 offen nt
    v_mfma_f32_16x16x32_bf16 v[36:39], v[124:127], v[16:19], 0
    v_add_f32_dpp v140, v27, v24 row_shl:15 row_mask:0xf bank_mask:0xf
    v_add_f32_dpp v31, v30, v31 quad_perm:[2,2,2,2] row_mask:0xf bank_mask:0xf
    v_add_f32_dpp v28, v29, v28 quad_perm:[1,1,1,1] row_mask:0xf bank_mask:0xf
    v_mov_b32_dpp v141, v141 row_shr:1 row_mask:0xf bank_mask:0xf
    ds_read_b32 v60, v61 offset:1536
    s_add_u32 s64, s64, 1
    v_readlane_b32 s61, v160, s64
    s_waitcnt lgkmcnt(0)
    v_readfirstlane_b32 s10, v60
    s_cmp_eq_u32 s10, 0
    s_cbranch_scc1 L_bk0
    s_cmp_eq_u32 s10, 1
    s_cbranch_scc1 L_bk1
    s_cmp_eq_u32 s10, 2
    s_cbranch_scc1 L_bk2
    s_branch L_bk3
L_bk2:
    v_xor_b32 v144, s61, v144
    s_waitcnt vmcnt(5)
    buffer_load_dwordx4 v[96:99], v144, s[44:47], 0 offen nt
    v_mfma_f32_16x16x32_bf16 v[24:27], v[64:67], v[16:19], 0
    v_add_f32_dpp v141, v31, v28 row_shl:15 row_mask:0xf bank_mask:0xf
    v_add_f32_dpp v35, v34, v35 quad_perm:[2,2,2,2] row_mask:0xf bank_mask:0xf
    v_add_f32_dpp v32, v33, v32 quad_perm:[1,1,1,1] row_mask:0xf bank_mask:0xf
    v_mov_b32_dpp v142, v142 row_shr:1 row_mask:0xf bank_mask:0xf
    v_xor_b32 v145, s61, v145
    s_waitcnt vmcnt(5)
    buffer_load_dwordx4 v[100:103], v145, s[44:47], 0 offen nt
    v_mfma_f32_16x16x32_bf16 v[28:31], v[68:71], v[16:19], 0
    v_add_f32_dpp v142, v35, v32 row_shl:15 row_mask:0xf bank_mask:0xf
    v_add_f32_dpp v39, v38, v39 quad_perm:[2,2,2,2] row_mask:0xf bank_mask:0xf
    v_add_f32_dpp v36, v37, v36 quad_perm:[1,1,1,1] row_mask:0xf bank_mask:0xf
    v_mov_b32_dpp v143, v143 row_shr:1 row_mask:0xf bank_mask:0xf
    v_xor_b32 v146, s61, v146
    s_waitcnt vmcnt(5)
    buffer_load_dwordx4 v[104:107], v146, s[44:47], 0 offen nt
    v_mfma_f32_16x16x32_bf16 v[32:35], v[72:75], v[16:19], 0
    v_add_f32_dpp v27, v26, v27 quad_perm:[2,2,2,2] row_mask:0xf bank_mask:0xf
    v_add_f32_dpp v24, v25, v24 quad_perm:[1,1,1,1] row_mask:0xf bank_mask:0xf
    v_mov_b32_dpp v128, v128 row_shr:1 row_mask:0xf bank_mask:0xf
    v_add_f32_dpp v143, v39, v36 row_shl:15 row_mask:0xf bank_mask:0xf
    v_xor_b32 v147, s61, v147
    s_waitcnt vmcnt(5)
    buffer_load_dwordx4 v[108:111], v147, s[44:47], 0 offen nt
    v_mfma_f32_16x16x32_bf16 v[36:39], v[76:79], v[16:19], 0
    v_add_f32_dpp v128, v27, v24 row_shl:15 row_mask:0xf bank_mask:0xf
    v_add_f32_dpp v31, v30, v31 quad_perm:[2,2,2,2] row_mask:0xf bank_mask:0xf
    v_add_f32_dpp v28, v29, v28 quad_perm:[1,1,1,1] row_mask:0xf bank_mask:0xf
    v_mov_b32_dpp v129, v129 row_shr:1 row_mask:0xf bank_mask:0xf
    v_xor_b32 v148, s61, v148
    s_waitcnt vmcnt(5)
    buffer_load_dwordx4 v[112:115], v148, s[44:47], 0 offen nt
    v_mfma_f32_16x16x32_bf16 v[24:27], v[80:83], v[16:19], 0
    v_add_f32_dpp v129, v31, v28 row_shl:15 row_mask:0xf bank_mask:0xf
    v_add_f32_dpp v35, v34, v35 quad_perm:[2,2,2,2] row_mask:0xf bank_mask:0xf
    v_add_f32_dpp v32, v33, v32 quad_perm:[1,1,1,1] row_mask:0xf bank_mask:0xf
    v_mov_b32_dpp v130, v130 row_shr:1 row_mask:0xf bank_mask:0xf
    v_xor_b32 v149, s61, v149
    s_waitcnt vmcnt(5)
    buffer_load_dwordx4 v[116:119], v149, s[44:47], 0 offen nt
    v_mfma_f32_16x16x32_bf16 v[28:31], v[84:87], v[16:19], 0
    v_add_f32_dpp v130, v35, v32 row_shl:15 row_mask:0xf bank_mask:0xf
    v_add_f32_dpp v39, v38, v39 quad_perm:[2,2,2,2] row_mask:0xf bank_mask:0xf
    v_add_f32_dpp v36, v37, v36 quad_perm:[1,1,1,1] row_mask:0xf bank_mask:0xf
    v_mov_b32_dpp v131, v131 row_shr:1 row_mask:0xf bank_mask:0xf
    v_xor_b32 v150, s61, v150
    s_waitcnt vmcnt(5)
    buffer_load_dwordx4 v[120:123], v150, s[44:47], 0 offen nt
    v_mfma_f32_16x16x32_bf16 v[32:35], v[88:91], v[16:19], 0
    v_add_f32_dpp v131, v39, v36 row_shl:15 row_mask:0xf bank_mask:0xf
    v_add_f32_dpp v27, v26, v27 quad_perm:[2,2,2,2] row_mask:0xf bank_mask:0xf
    v_add_f32_dpp v24, v25, v24 quad_perm:[1,1,1,1] row_mask:0xf bank_mask:0xf
    v_mov_b32_dpp v132, v132 row_shr:1 row_mask:0xf bank_mask:0xf
    v_xor_b32 v151, s61, v151
    s_waitcnt vmcnt(5)
    buffer_load_dwordx4 v[124:127], v151, s[44:47], 0 offen nt
    v_mfma_f32_16x16x32_bf16 v[36:39], v[92:95], v[16:19], 0
    v_add_f32_dpp v132, v27, v24 row_shl:15 row_mask:0xf bank_mask:0xf
    v_add_f32_dpp v31, v30, v31 quad_perm:[2,2,2,2] row_mask:0xf bank_mask:0xf
    v_add_f32_dpp v28, v29, v28 quad_perm:[1,1,1,1] row_mask:0xf bank_mask:0xf
    v_mov_b32_dpp v133, v133 row_shr:1 row_mask:0xf bank_mask:0xf
    s_bitcmp1_b32 s63, s14
    s_cbranch_scc0 L_bkc2
    s_barrier
L_bkc2:
    s_add_u32 s64, s64, 1
    v_readlane_b32 s61, v160, s64
    s_sub_u32 s14, s14, 1
    s_cmp_eq_u32 s14, 0
    s_cbranch_scc1 L_bkend
    v_xor_b32 v144, s61, v144
    s_waitcnt vmcnt(5)
    buffer_load_dwordx4 v[64:67], v144, s[44:47], 0 offen nt
    v_mfma_f32_16x16x32_bf16 v[24:27], v[96:99], v[16:19], 0
    v_add_f32_dpp v133, v31, v28 row_shl:15 row_mask:0xf bank_mask:0xf
    v_add_f32_dpp v35, v34, v35 quad_perm:[2,2,2,2] row_mask:0xf bank_mask:0xf
    v_add_f32_dpp v32, v33, v32 quad_perm:[1,1,1,1] row_mask:0xf bank_mask:0xf
    v_mov_b32_dpp v134, v134 row_shr:1 row_mask:0xf bank_mask:0xf
    v_xor_b32 v145, s61, v145
    s_waitcnt vmcnt(5)
    buffer_load_dwordx4 v[68:71], v145, s[44:47], 0 offen nt
    v_mfma_f32_16x16x32_bf16 v[28:31], v[100:103], v[16:19], 0
    v_add_f32_dpp v134, v35, v32 row_shl:15 row_mask:0xf bank_mask:0xf
    v_add_f32_dpp v39, v38, v39 quad_perm:[2,2,2,2] row_mask:0xf bank_mask:0xf
    v_add_f32_dpp v36, v37, v36 quad_perm:[1,1,1,1] row_mask:0xf bank_mask:0xf
    v_mov_b32_dpp v135, v135 row_shr:1 row_mask:0xf bank_mask:0xf
    v_xor_b32 v146, s61, v146
    s_waitcnt vmcnt(5)
    buffer_load_dwordx4 v[72:75], v146, s[44:47], 0 offen nt
    v_mfma_f32_16x16x32_bf16 v[32:35], v[104:107], v[16:19], 0
    v_add_f32_dpp v27, v26, v27 quad_perm:[2,2,2,2] row_mask:0xf bank_mask:0xf
    v_add_f32_dpp v24, v25, v24 quad_perm:[1,1,1,1] row_mask:0xf bank_mask:0xf
    v_mov_b32_dpp v136, v136 row_shr:1 row_mask:0xf bank_mask:0xf
    v_add_f32_dpp v135, v39, v36 row_shl:15 row_mask:0xf bank_mask:0xf
    v_xor_b32 v147, s61, v147
    s_waitcnt vmcnt(5)
    buffer_load_dwordx4 v[76:79], v147, s[44:47], 0 offen nt
    v_mfma_f32_16x16x32_bf16 v[36:39], v[108:111], v[16:19], 0
    v_add_f32_dpp v136, v27, v24 row_shl:15 row_mask:0xf bank_mask:0xf
    v_add_f32_dpp v31, v30, v31 quad_perm:[2,2,2,2] row_mask:0xf bank_mask:0xf
    v_add_f32_dpp v28, v29, v28 quad_perm:[1,1,1,1] row_mask:0xf bank_mask:0xf
    v_mov_b32_dpp v137, v137 row_shr:1 row_mask:0xf bank_mask:0xf
    v_xor_b32 v148, s61, v148
    s_waitcnt vmcnt(5)
    buffer_load_dwordx4 v[80:83], v148, s[44:47], 0 offen nt
    v_mfma_f32_16x16x32_bf16 v[24:27], v[112:115], v[16:19], 0
    v_add_f32_dpp v137, v31, v28 row_shl:15 row_mask:0xf bank_mask:0xf
    v_add_f32_dpp v35, v34, v35 quad_perm:[2,2,2,2] row_mask:0xf bank_mask:0xf
    v_add_f32_dpp v32, v33, v32 quad_perm:[1,1,1,1] row_mask:0xf bank_mask:0xf
    v_mov_b32_dpp v138, v138 row_shr:1 row_mask:0xf bank_mask:0xf
    v_xor_b32 v149, s61, v149
    s_waitcnt vmcnt(5)
    buffer_load_dwordx4 v[84:87], v149, s[44:47], 0 offen nt
    v_mfma_f32_16x16x32_bf16 v[28:31], v[116:119], v[16:19], 0
    v_add_f32_dpp v138, v35, v32 row_shl:15 row_mask:0xf bank_mask:0xf
    v_add_f32_dpp v39, v38, v39 quad_perm:[2,2,2,2] row_mask:0xf bank_mask:0xf
    v_add_f32_dpp v36, v37, v36 quad_perm:[1,1,1,1] row_mask:0xf bank_mask:0xf
    v_mov_b32_dpp v139, v139 row_shr:1 row_mask:0xf bank_mask:0xf
    v_xor_b32 v150, s61, v150
    s_waitcnt vmcnt(5)
    buffer_load_dwordx4 v[88:91], v150, s[44:47], 0 offen nt
    v_mfma_f32_16x16x32_bf16 v[32:35], v[120:123], v[16:19], 0
    v_add_f32_dpp v139, v39, v36 row_shl:15 row_mask:0xf bank_mask:0xf
    v_add_f32_dpp v27, v26, v27 quad_perm:[2,2,2,2] row_mask:0xf bank_mask:0xf
    v_add_f32_dpp v24, v25, v24 quad_perm:[1,1,1,1] row_mask:0xf bank_mask:0xf
    v_mov_b32_dpp v140, v140 row_shr:1 row_mask:0xf bank_mask:0xf
    v_xor_b32 v151, s61, v151
    s_waitcnt vmcnt(5)
    buffer_load_dwordx4 v[92:95], v151, s[44:47], 0 offen nt
    v_mfma_f32_16x16x32_bf16 v[36:39], v[124:127], v[16:19], 0
    v_add_f32_dpp v140, v27, v24 row_shl:15 row_mask:0xf bank_mask:0xf
    v_add_f32_dpp v31, v30, v31 quad_perm:[2,2,2,2] row_mask:0xf bank_mask:0xf
    v_add_f32_dpp v28, v29, v28 quad_perm:[1,1,1,1] row_mask:0xf bank_mask:0xf
    v_mov_b32_dpp v141, v141 row_shr:1 row_mask:0xf bank_mask:0xf
    ds_read_b32 v60, v61 offset:1536
    s_add_u32 s64, s64, 1
    v_readlane_b32 s61, v160, s64
    s_waitcnt lgkmcnt(0)
    v_readfirstlane_b32 s10, v60
    s_cmp_eq_u32 s10, 0
    s_cbranch_scc1 L_bk0
    s_cmp_eq_u32 s10, 1
    s_cbranch_scc1 L_bk1
    s_cmp_eq_u32 s10, 2
    s_cbranch_scc1 L_bk2
    s_branch L_bk3
L_bk3:
    v_xor_b32 v144, s61, v144
    s_waitcnt vmcnt(6)
    buffer_load_dwordx4 v[96:99], v144, s[44:47], 0 offen nt
    v_mfma_f32_16x16x32_bf16 v[24:27], v[64:67], v[16:19], 0
    v_add_f32_dpp v141, v31, v28 row_shl:15 row_mask:0xf bank_mask:0xf
    v_add_f32_dpp v35, v34, v35 quad_perm:[2,2,2,2] row_mask:0xf bank_mask:0xf
    v_add_f32_dpp v32, v33, v32 quad_perm:[1,1,1,1] row_mask:0xf bank_mask:0xf
    v_mov_b32_dpp v142, v142 row_shr:1 row_mask:0xf bank_mask:0xf
    v_xor_b32 v145, s61, v145
    s_waitcnt vmcnt(6)
    buffer_load_dwordx4 v[100:103], v145, s[44:47], 0 offen nt
    v_mfma_f32_16x16x32_bf16 v[28:31], v[68:71], v[16:19], 0
    v_add_f32_dpp v142, v35, v32 row_shl:15 row_mask:0xf bank_mask:0xf
    v_add_f32_dpp v39, v38, v39 quad_perm:[2,2,2,2] row_mask:0xf bank_mask:0xf
    v_add_f32_dpp v36, v37, v36 quad_perm:[1,1,1,1] row_mask:0xf bank_mask:0xf
    v_mov_b32_dpp v143, v143 row_shr:1 row_mask:0xf bank_mask:0xf
    v_xor_b32 v146, s61, v146
    s_waitcnt vmcnt(6)
    buffer_load_dwordx4 v[104:107], v146, s[44:47], 0 offen nt
    v_mfma_f32_16x16x32_bf16 v[32:35], v[72:75], v[16:19], 0
    v_add_f32_dpp v27, v26, v27 quad_perm:[2,2,2,2] row_mask:0xf bank_mask:0xf
    v_add_f32_dpp v24, v25, v24 quad_perm:[1,1,1,1] row_mask:0xf bank_mask:0xf
    v_mov_b32_dpp v128, v128 row_shr:1 row_mask:0xf bank_mask:0xf
    v_add_f32_dpp v143, v39, v36 row_shl:15 row_mask:0xf bank_mask:0xf
    v_xor_b32 v147, s61, v147
    s_waitcnt vmcnt(6)
    buffer_load_dwordx4 v[108:111], v147, s[44:47], 0 offen nt
    v_mfma_f32_16x16x32_bf16 v[36:39], v[76:79], v[16:19], 0
    v_add_f32_dpp v128, v27, v24 row_shl:15 row_mask:0xf bank_mask:0xf
    v_add_f32_dpp v31, v30, v31 quad_perm:[2,2,2,2] row_mask:0xf bank_mask:0xf
    v_add_f32_dpp v28, v29, v28 quad_perm:[1,1,1,1] row_mask:0xf bank_mask:0xf
    v_mov_b32_dpp v129, v129 row_shr:1 row_mask:0xf bank_mask:0xf
    v_xor_b32 v148, s61, v148
    s_waitcnt vmcnt(6)
    buffer_load_dwordx4 v[112:115], v148, s[44:47], 0 offen nt
    v_mfma_f32_16x16x32_bf16 v[24:27], v[80:83], v[16:19], 0
    v_add_f32_dpp v129, v31, v28 row_shl:15 row_mask:0xf bank_mask:0xf
    v_add_f32_dpp v35, v34, v35 quad_perm:[2,2,2,2] row_mask:0xf bank_mask:0xf
    v_add_f32_dpp v32, v33, v32 quad_perm:[1,1,1,1] row_mask:0xf bank_mask:0xf
    v_mov_b32_dpp v130, v130 row_shr:1 row_mask:0xf bank_mask:0xf
    v_xor_b32 v149, s61, v149
    s_waitcnt vmcnt(6)
    buffer_load_dwordx4 v[116:119], v149, s[44:47], 0 offen nt
    v_mfma_f32_16x16x32_bf16 v[28:31], v[84:87], v[16:19], 0
    v_add_f32_dpp v130, v35, v32 row_shl:15 row_mask:0xf bank_mask:0xf
    v_add_f32_dpp v39, v38, v39 quad_perm:[2,2,2,2] row_mask:0xf bank_mask:0xf
    v_add_f32_dpp v36, v37, v36 quad_perm:[1,1,1,1] row_mask:0xf bank_mask:0xf
    v_mov_b32_dpp v131, v131 row_shr:1 row_mask:0xf bank_mask:0xf
    v_xor_b32 v150, s61, v150
    s_waitcnt vmcnt(6)
    buffer_load_dwordx4 v[120:123], v150, s[44:47], 0 offen nt
    v_mfma_f32_16x16x32_bf16 v[32:35], v[88:91], v[16:19], 0
    v_add_f32_dpp v131, v39, v36 row_shl:15 row_mask:0xf bank_mask:0xf
    v_add_f32_dpp v27, v26, v27 quad_perm:[2,2,2,2] row_mask:0xf bank_mask:0xf
    v_add_f32_dpp v24, v25, v24 quad_perm:[1,1,1,1] row_mask:0xf bank_mask:0xf
    v_mov_b32_dpp v132, v132 row_shr:1 row_mask:0xf bank_mask:0xf
    v_xor_b32 v151, s61, v151
    s_waitcnt vmcnt(6)
    buffer_load_dwordx4 v[124:127], v151, s[44:47], 0 offen nt
    v_mfma_f32_16x16x32_bf16 v[36:39], v[92:95], v[16:19], 0
    v_add_f32_dpp v132, v27, v24 row_shl:15 row_mask:0xf bank_mask:0xf
    v_add_f32_dpp v31, v30, v31 quad_perm:[2,2,2,2] row_mask:0xf bank_mask:0xf
    v_add_f32_dpp v28, v29, v28 quad_perm:[1,1,1,1] row_mask:0xf bank_mask:0xf
    v_mov_b32_dpp v133, v133 row_shr:1 row_mask:0xf bank_mask:0xf
    s_bitcmp1_b32 s63, s14
    s_cbranch_scc0 L_bkc3
    s_barrier
L_bkc3:
    s_add_u32 s64, s64, 1
    v_readlane_b32 s61, v160, s64
    s_sub_u32 s14, s14, 1
    s_cmp_eq_u32 s14, 0
    s_cbranch_scc1 L_bkend
    v_xor_b32 v144, s61, v144
    s_waitcnt vmcnt(6)
    buffer_load_dwordx4 v[64:67], v144, s[44:47], 0 offen nt
    v_mfma_f32_16x16x32_bf16 v[24:27], v[96:99], v[16:19], 0
    v_add_f32_dpp v133, v31, v28 row_shl:15 row_mask:0xf bank_mask:0xf
    v_add_f32_dpp v35, v34, v35 quad_perm:[2,2,2,2] row_mask:0xf bank_mask:0xf
    v_add_f32_dpp v32, v33, v32 quad_perm:[1,1,1,1] row_mask:0xf bank_mask:0xf
    v_mov_b32_dpp v134, v134 row_shr:1 row_mask:0xf bank_mask:0xf
    v_xor_b32 v145, s61, v145
    s_waitcnt vmcnt(6)
    buffer_load_dwordx4 v[68:71], v145, s[44:47], 0 offen nt
    v_mfma_f32_16x16x32_bf16 v[28:31], v[100:103], v[16:19], 0
    v_add_f32_dpp v134, v35, v32 row_shl:15 row_mask:0xf bank_mask:0xf
    v_add_f32_dpp v39, v38, v39 quad_perm:[2,2,2,2] row_mask:0xf bank_mask:0xf
    v_add_f32_dpp v36, v37, v36 quad_perm:[1,1,1,1] row_mask:0xf bank_mask:0xf
    v_mov_b32_dpp v135, v135 row_shr:1 row_mask:0xf bank_mask:0xf
    v_xor_b32 v146, s61, v146
    s_waitcnt vmcnt(6)
    buffer_load_dwordx4 v[72:75], v146, s[44:47], 0 offen nt
    v_mfma_f32_16x16x32_bf16 v[32:35], v[104:107], v[16:19], 0
    v_add_f32_dpp v27, v26, v27 quad_perm:[2,2,2,2] row_mask:0xf bank_mask:0xf
    v_add_f32_dpp v24, v25, v24 quad_perm:[1,1,1,1] row_mask:0xf bank_mask:0xf
    v_mov_b32_dpp v136, v136 row_shr:1 row_mask:0xf bank_mask:0xf
    v_add_f32_dpp v135, v39, v36 row_shl:15 row_mask:0xf bank_mask:0xf
    v_xor_b32 v147, s61, v147
    s_waitcnt vmcnt(6)
    buffer_load_dwordx4 v[76:79], v147, s[44:47], 0 offen nt
    v_mfma_f32_16x16x32_bf16 v[36:39], v[108:111], v[16:19], 0
    v_add_f32_dpp v136, v27, v24 row_shl:15 row_mask:0xf bank_mask:0xf
    v_add_f32_dpp v31, v30, v31 quad_perm:[2,2,2,2] row_mask:0xf bank_mask:0xf
    v_add_f32_dpp v28, v29, v28 quad_perm:[1,1,1,1] row_mask:0xf bank_mask:0xf
    v_mov_b32_dpp v137, v137 row_shr:1 row_mask:0xf bank_mask:0xf
    v_xor_b32 v148, s61, v148
    s_waitcnt vmcnt(6)
    buffer_load_dwordx4 v[80:83], v148, s[44:47], 0 offen nt
    v_mfma_f32_16x16x32_bf16 v[24:27], v[112:115], v[16:19], 0
    v_add_f32_dpp v137, v31, v28 row_shl:15 row_mask:0xf bank_mask:0xf
    v_add_f32_dpp v35, v34, v35 quad_perm:[2,2,2,2] row_mask:0xf bank_mask:0xf
    v_add_f32_dpp v32, v33, v32 quad_perm:[1,1,1,1] row_mask:0xf bank_mask:0xf
    v_mov_b32_dpp v138, v138 row_shr:1 row_mask:0xf bank_mask:0xf
    v_xor_b32 v149, s61, v149
    s_waitcnt vmcnt(6)
    buffer_load_dwordx4 v[84:87], v149, s[44:47], 0 offen nt
    v_mfma_f32_16x16x32_bf16 v[28:31], v[116:119], v[16:19], 0
    v_add_f32_dpp v138, v35, v32 row_shl:15 row_mask:0xf bank_mask:0xf
    v_add_f32_dpp v39, v38, v39 quad_perm:[2,2,2,2] row_mask:0xf bank_mask:0xf
    v_add_f32_dpp v36, v37, v36 quad_perm:[1,1,1,1] row_mask:0xf bank_mask:0xf
    v_mov_b32_dpp v139, v139 row_shr:1 row_mask:0xf bank_mask:0xf
    v_xor_b32 v150, s61, v150
    s_waitcnt vmcnt(6)
    buffer_load_dwordx4 v[88:91], v150, s[44:47], 0 offen nt
    v_mfma_f32_16x16x32_bf16 v[32:35], v[120:123], v[16:19], 0
    v_add_f32_dpp v139, v39, v36 row_shl:15 row_mask:0xf bank_mask:0xf
    v_add_f32_dpp v27, v26, v27 quad_perm:[2,2,2,2] row_mask:0xf bank_mask:0xf
    v_add_f32_dpp v24, v25, v24 quad_perm:[1,1,1,1] row_mask:0xf bank_mask:0xf
    v_mov_b32_dpp v140, v140 row_shr:1 row_mask:0xf bank_mask:0xf
    v_xor_b32 v151, s61, v151
    s_waitcnt vmcnt(6)
    buffer_load_dwordx4 v[92:95], v151, s[44:47], 0 offen nt
    v_mfma_f32_16x16x32_bf16 v[36:39], v[124:127], v[16:19], 0
    v_add_f32_dpp v140, v27, v24 row_shl:15 row_mask:0xf bank_mask:0xf
    v_add_f32_dpp v31, v30, v31 quad_perm:[2,2,2,2] row_mask:0xf bank_mask:0xf
    v_add_f32_dpp v28, v29, v28 quad_perm:[1,1,1,1] row_mask:0xf bank_mask:0xf
    v_mov_b32_dpp v141, v141 row_shr:1 row_mask:0xf bank_mask:0xf
    ds_read_b32 v60, v61 offset:1536
    s_add_u32 s64, s64, 1
    v_readlane_b32 s61, v160, s64
    s_waitcnt lgkmcnt(0)
    v_readfirstlane_b32 s10, v60
    s_cmp_eq_u32 s10, 0
    s_cbranch_scc1 L_bk0
    s_cmp_eq_u32 s10, 1
    s_cbranch_scc1 L_bk1
    s_cmp_eq_u32 s10, 2
    s_cbranch_scc1 L_bk2
    s_branch L_bk3
.p2align 12
L_bkend:
    v_xor_b32 v152, s65, v152
    s_waitcnt vmcnt(4)
    buffer_load_dwordx4 v[64:67], v152, s[48:51], 0 offen nt
    v_mfma_f32_16x16x32_bf16 v[24:27], v[96:99], v[16:19], 0
    v_add_f32_dpp v133, v31, v28 row_shl:15 row_mask:0xf bank_mask:0xf
    v_add_f32_dpp v35, v34, v35 quad_perm:[2,2,2,2] row_mask:0xf bank_mask:0xf
    v_add_f32_dpp v32, v33, v32 quad_perm:[1,1,1,1] row_mask:0xf bank_mask:0xf
    v_mov_b32_dpp v134, v134 row_shr:1 row_mask:0xf bank_mask:0xf
    v_xor_b32 v153, s65, v153
    s_waitcnt vmcnt(4)
    buffer_load_dwordx4 v[68:71], v153, s[48:51], 0 offen nt
    v_mfma_f32_16x16x32_bf16 v[28:31], v[100:103], v[16:19], 0
    v_add_f32_dpp v134, v35, v32 row_shl:15 row_mask:0xf bank_mask:0xf
    v_add_f32_dpp v39, v38, v39 quad_perm:[2,2,2,2] row_mask:0xf bank_mask:0xf
    v_add_f32_dpp v36, v37, v36 quad_perm:[1,1,1,1] row_mask:0xf bank_mask:0xf
    v_mov_b32_dpp v135, v135 row_shr:1 row_mask:0xf bank_mask:0xf
    v_xor_b32 v154, s65, v154
    s_waitcnt vmcnt(4)
    buffer_load_dwordx4 v[72:75], v154, s[48:51], 0 offen nt
    v_mfma_f32_16x16x32_bf16 v[32:35], v[104:107], v[16:19], 0
    v_add_f32_dpp v27, v26, v27 quad_perm:[2,2,2,2] row_mask:0xf bank_mask:0xf
    v_add_f32_dpp v24, v25, v24 quad_perm:[1,1,1,1] row_mask:0xf bank_mask:0xf
    v_mov_b32_dpp v136, v136 row_shr:1 row_mask:0xf bank_mask:0xf
    v_add_f32_dpp v135, v39, v36 row_shl:15 row_mask:0xf bank_mask:0xf
    v_xor_b32 v155, s65, v155
    s_waitcnt vmcnt(4)
    buffer_load_dwordx4 v[76:79], v155, s[48:51], 0 offen nt
    v_mfma_f32_16x16x32_bf16 v[36:39], v[108:111], v[16:19], 0
    v_add_f32_dpp v136, v27, v24 row_shl:15 row_mask:0xf bank_mask:0xf
    v_add_f32_dpp v31, v30, v31 quad_perm:[2,2,2,2] row_mask:0xf bank_mask:0xf
    v_add_f32_dpp v28, v29, v28 quad_perm:[1,1,1,1] row_mask:0xf bank_mask:0xf
    v_mov_b32_dpp v137, v137 row_shr:1 row_mask:0xf bank_mask:0xf
    v_xor_b32 v156, s65, v156
    s_waitcnt vmcnt(4)
    buffer_load_dwordx4 v[80:83], v156, s[48:51], 0 offen nt
    v_mfma_f32_16x16x32_bf16 v[24:27], v[112:115], v[16:19], 0
    v_add_f32_dpp v137, v31, v28 row_shl:15 row_mask:0xf bank_mask:0xf
    v_add_f32_dpp v35, v34, v35 quad_perm:[2,2,2,2] row_mask:0xf bank_mask:0xf
    v_add_f32_dpp v32, v33, v32 quad_perm:[1,1,1,1] row_mask:0xf bank_mask:0xf
    v_mov_b32_dpp v138, v138 row_shr:1 row_mask:0xf bank_mask:0xf
    v_xor_b32 v157, s65, v157
    s_waitcnt vmcnt(4)
    buffer_load_dwordx4 v[84:87], v157, s[48:51], 0 offen nt
    v_mfma_f32_16x16x32_bf16 v[28:31], v[116:119], v[16:19], 0
    v_add_f32_dpp v138, v35, v32 row_shl:15 row_mask:0xf bank_mask:0xf
    v_add_f32_dpp v39, v38, v39 quad_perm:[2,2,2,2] row_mask:0xf bank_mask:0xf
    v_add_f32_dpp v36, v37, v36 quad_perm:[1,1,1,1] row_mask:0xf bank_mask:0xf
    v_mov_b32_dpp v139, v139 row_shr:1 row_mask:0xf bank_mask:0xf
    v_xor_b32 v158, s65, v158
    s_waitcnt vmcnt(4)
    buffer_load_dwordx4 v[88:91], v158, s[48:51], 0 offen nt
    v_mfma_f32_16x16x32_bf16 v[32:35], v[120:123], v[16:19], 0
    v_add_f32_dpp v139, v39, v36 row_shl:15 row_mask:0xf bank_mask:0xf
    v_add_f32_dpp v27, v26, v27 quad_perm:[2,2,2,2] row_mask:0xf bank_mask:0xf
    v_add_f32_dpp v24, v25, v24 quad_perm:[1,1,1,1] row_mask:0xf bank_mask:0xf
    v_mov_b32_dpp v140, v140 row_shr:1 row_mask:0xf bank_mask:0xf
    v_xor_b32 v159, s65, v159
    s_waitcnt vmcnt(4)
    buffer_load_dwordx4 v[92:95], v159, s[48:51], 0 offen nt
    v_mfma_f32_16x16x32_bf16 v[36:39], v[124:127], v[16:19], 0
    v_add_f32_dpp v140, v27, v24 row_shl:15 row_mask:0xf bank_mask:0xf
    v_add_f32_dpp v31, v30, v31 quad_perm:[2,2,2,2] row_mask:0xf bank_mask:0xf
    v_add_f32_dpp v28, v29, v28 quad_perm:[1,1,1,1] row_mask:0xf bank_mask:0xf
    v_mov_b32_dpp v141, v141 row_shr:1 row_mask:0xf bank_mask:0xf
    s_mov_b32 s64, 1
    s_mov_b32 s61, 0x8400
    s_mov_b32 s14, 15
    v_xor_b32 v152, s61, v152
    s_waitcnt vmcnt(4)
    buffer_load_dwordx4 v[96:99], v152, s[48:51], 0 offen nt
    v_add_f32_dpp v141, v31, v28 row_shl:15 row_mask:0xf bank_mask:0xf
    v_add_f32_dpp v35, v34, v35 quad_perm:[2,2,2,2] row_mask:0xf bank_mask:0xf
    v_add_f32_dpp v32, v33, v32 quad_perm:[1,1,1,1] row_mask:0xf bank_mask:0xf
    v_mov_b32_dpp v142, v142 row_shr:1 row_mask:0xf bank_mask:0xf
    s_nop 1
    v_add_f32_dpp v142, v35, v32 row_shl:15 row_mask:0xf bank_mask:0xf
    v_add_f32_dpp v39, v38, v39 quad_perm:[2,2,2,2] row_mask:0xf bank_mask:0xf
    v_add_f32_dpp v36, v37, v36 quad_perm:[1,1,1,1] row_mask:0xf bank_mask:0xf
    v_mov_b32_dpp v143, v143 row_shr:1 row_mask:0xf bank_mask:0xf
    s_nop 1
    v_add_f32_dpp v143, v39, v36 row_shl:15 row_mask:0xf bank_mask:0xf
    v_max3_f32 v36, v128, v129, v130
    v_max3_f32 v36, v36, v131, v132
    v_max3_f32 v36, v36, v133, v134
    v_max3_f32 v36, v36, v135, v136
    v_max3_f32 v36, v36, v137, v138
    v_max3_f32 v36, v36, v139, v140
    v_max3_f32 v36, v36, v141, v142
    v_max_f32 v36, v36, v143
    s_nop 1
    v_max_f32_dpp v36, v36, v36 row_ror:8 row_mask:0xf bank_mask:0xf
    s_nop 1
    v_max_f32_dpp v36, v36, v36 row_ror:4 row_mask:0xf bank_mask:0xf
    s_nop 1
    v_max_f32_dpp v36, v36, v36 row_ror:2 row_mask:0xf bank_mask:0xf
    s_nop 1
    v_max_f32_dpp v36, v36, v36 row_ror:1 row_mask:0xf bank_mask:0xf
    v_mov_b32 v5, v36
    v_xor_b32 v153, s61, v153
    s_waitcnt vmcnt(4)
    buffer_load_dwordx4 v[100:103], v153, s[48:51], 0 offen nt
    v_permlane32_swap_b32 v5, v36
    v_max_f32 v36, v36, v5
    v_mov_b32 v5, v36
    s_nop 1
    v_permlane16_swap_b32 v5, v36
    v_max_f32 v36, v36, v5
    v_mul_f32 v38, s9, v36
    v_fma_f32 v128, v128, s9, -v38
    v_fma_f32 v129, v129, s9, -v38
    v_fma_f32 v130, v130, s9, -v38
    v_fma_f32 v131, v131, s9, -v38
    v_fma_f32 v132, v132, s9, -v38
    v_fma_f32 v133, v133, s9, -v38
    v_fma_f32 v134, v134, s9, -v38
    v_fma_f32 v135, v135, s9, -v38
    v_fma_f32 v136, v136, s9, -v38
    v_fma_f32 v137, v137, s9, -v38
    v_fma_f32 v138, v138, s9, -v38
    v_fma_f32 v139, v139, s9, -v38
    v_fma_f32 v140, v140, s9, -v38
    v_fma_f32 v141, v141, s9, -v38
    v_fma_f32 v142, v142, s9, -v38
    v_fma_f32 v143, v143, s9, -v38
    v_exp_f32 v128, v128
    v_xor_b32 v154, s61, v154
    s_waitcnt vmcnt(4)
    buffer_load_dwordx4 v[104:107], v154, s[48:51], 0 offen nt
    v_exp_f32 v129, v129
    v_exp_f32 v130, v130
    v_exp_f32 v131, v131
    v_exp_f32 v132, v132
    v_exp_f32 v133, v133
    v_exp_f32 v134, v134
    v_exp_f32 v135, v135
    v_exp_f32 v136, v136
    v_exp_f32 v137, v137
    v_exp_f32 v138, v138
    v_exp_f32 v139, v139
    v_exp_f32 v140, v140
    v_exp_f32 v141, v141
    v_exp_f32 v142, v142
    v_exp_f32 v143, v143
    v_add_f32 v37, v128, v129
    v_add_f32 v37, v37, v130
    v_add_f32 v37, v37, v131
    v_add_f32 v37, v37, v132
    v_add_f32 v37, v37, v133
    v_add_f32 v37, v37, v134
    v_add_f32 v37, v37, v135
    v_add_f32 v37, v37, v136
    v_xor_b32 v155, s61, v155
    s_waitcnt vmcnt(4)
    buffer_load_dwordx4 v[108:111], v155, s[48:51], 0 offen nt
    v_add_f32 v37, v37, v137
    v_add_f32 v37, v37, v138
    v_add_f32 v37, v37, v139
    v_add_f32 v37, v37, v140
    v_add_f32 v37, v37, v141
    v_add_f32 v37, v37, v142
    v_add_f32 v37, v37, v143
    v_cvt_pk_bf16_f32 v128, v128, v128
    v_cvt_pk_bf16_f32 v129, v129, v129
    v_cvt_pk_bf16_f32 v130, v130, v130
    v_cvt_pk_bf16_f32 v131, v131, v131
    v_cvt_pk_bf16_f32 v132, v132, v132
    v_cvt_pk_bf16_f32 v133, v133, v133
    v_cvt_pk_bf16_f32 v134, v134, v134
    v_cvt_pk_bf16_f32 v135, v135, v135
    v_cvt_pk_bf16_f32 v136, v136, v136
    v_cvt_pk_bf16_f32 v137, v137, v137
    v_cvt_pk_bf16_f32 v138, v138, v138
    v_cvt_pk_bf16_f32 v139, v139, v139
    v_cvt_pk_bf16_f32 v140, v140, v140
    v_cvt_pk_bf16_f32 v141, v141, v141
    v_cvt_pk_bf16_f32 v142, v142, v142
    v_cvt_pk_bf16_f32 v143, v143, v143
    v_xor_b32 v156, s61, v156
    s_waitcnt vmcnt(4)
    buffer_load_dwordx4 v[112:115], v156, s[48:51], 0 offen nt
    v_and_b32_dpp v40, v128, v8 row_newbcast:15 row_mask:0xf bank_mask:0xf
    v_and_b32_dpp v41, v128, v9 row_newbcast:15 row_mask:0xf bank_mask:0xf
    v_and_b32_dpp v42, v128, v10 row_newbcast:15 row_mask:0xf bank_mask:0xf
    v_and_b32_dpp v43, v128, v11 row_newbcast:15 row_mask:0xf bank_mask:0xf
    v_mov_b32_dpp v128, v128 row_shr:1 row_mask:0xf bank_mask:0xf
    s_nop 0
    v_mfma_f32_16x16x32_bf16 v[32:35], v[40:43], v[64:67], 0
    v_and_b32_dpp v44, v129, v8 row_newbcast:15 row_mask:0xf bank_mask:0xf
    v_and_b32_dpp v45, v129, v9 row_newbcast:15 row_mask:0xf bank_mask:0xf
    v_and_b32_dpp v46, v129, v10 row_newbcast:15 row_mask:0xf bank_mask:0xf
    v_and_b32_dpp v47, v129, v11 row_newbcast:15 row_mask:0xf bank_mask:0xf
    v_mov_b32_dpp v129, v129 row_shr:1 row_mask:0xf bank_mask:0xf
    s_nop 0
    v_mfma_f32_16x16x32_bf16 v[32:35], v[44:47], v[68:71], v[32:35]
    v_xor_b32 v157, s61, v157
    s_waitcnt vmcnt(4)
    buffer_load_dwordx4 v[116:119], v157, s[48:51], 0 offen nt
    v_and_b32_dpp v40, v130, v8 row_newbcast:15 row_mask:0xf bank_mask:0xf
    v_and_b32_dpp v41, v130, v9 row_newbcast:15 row_mask:0xf bank_mask:0xf
    v_and_b32_dpp v42, v130, v10 row_newbcast:15 row_mask:0xf bank_mask:0xf
    v_and_b32_dpp v43, v130, v11 row_newbcast:15 row_mask:0xf bank_mask:0xf
    v_mov_b32_dpp v130, v130 row_shr:1 row_mask:0xf bank_mask:0xf
    s_nop 0
    v_mfma_f32_16x16x32_bf16 v[32:35], v[40:43], v[72:75], v[32:35]
    v_and_b32_dpp v44, v131, v8 row_newbcast:15 row_mask:0xf bank_mask:0xf
    v_and_b32_dpp v45, v131, v9 row_newbcast:15 row_mask:0xf bank_mask:0xf
    v_and_b32_dpp v46, v131, v10 row_newbcast:15 row_mask:0xf bank_mask:0xf
    v_and_b32_dpp v47, v131, v11 row_newbcast:15 row_mask:0xf bank_mask:0xf
    v_mov_b32_dpp v131, v131 row_shr:1 row_mask:0xf bank_mask:0xf
    s_nop 0
    v_mfma_f32_16x16x32_bf16 v[32:35], v[44:47], v[76:79], v[32:35]
    v_add_f32_dpp v37, v37, v37 row_ror:8 row_mask:0xf bank_mask:0xf
    s_nop 1
    v_add_f32_dpp v37, v37, v37 row_ror:4 row_mask:0xf bank_mask:0xf
    s_nop 1
    v_add_f32_dpp v37, v37, v37 row_ror:2 row_mask:0xf bank_mask:0xf
    s_nop 1
    v_add_f32_dpp v37, v37, v37 row_ror:1 row_mask:0xf bank_mask:0xf
    v_mov_b32 v5, v37
    s_nop 1
    v_permlane32_swap_b32 v5, v37
    v_add_f32 v37, v37, v5
    v_mov_b32 v5, v37
    s_nop 1
    v_permlane16_swap_b32 v5, v37
    v_add_f32 v37, v37, v5
    s_mov_b64 exec, 1
    ds_write_b64 v58, v[36:37] offset:1280
    s_mov_b64 exec, -1
    v_xor_b32 v158, s61, v158
    s_waitcnt vmcnt(4)
    buffer_load_dwordx4 v[120:123], v158, s[48:51], 0 offen nt
    v_and_b32_dpp v40, v132, v8 row_newbcast:15 row_mask:0xf bank_mask:0xf
    v_and_b32_dpp v41, v132, v9 row_newbcast:15 row_mask:0xf bank_mask:0xf
    v_and_b32_dpp v42, v132, v10 row_newbcast:15 row_mask:0xf bank_mask:0xf
    v_and_b32_dpp v43, v132, v11 row_newbcast:15 row_mask:0xf bank_mask:0xf
    v_mov_b32_dpp v132, v132 row_shr:1 row_mask:0xf bank_mask:0xf
    s_nop 0
    v_mfma_f32_16x16x32_bf16 v[32:35], v[40:43], v[80:83], v[32:35]
    v_and_b32_dpp v44, v133, v8 row_newbcast:15 row_mask:0xf bank_mask:0xf
    v_and_b32_dpp v45, v133, v9 row_newbcast:15 row_mask:0xf bank_mask:0xf
    v_and_b32_dpp v46, v133, v10 row_newbcast:15 row_mask:0xf bank_mask:0xf
    v_and_b32_dpp v47, v133, v11 row_newbcast:15 row_mask:0xf bank_mask:0xf
    v_mov_b32_dpp v133, v133 row_shr:1 row_mask:0xf bank_mask:0xf
    s_nop 0
    v_mfma_f32_16x16x32_bf16 v[32:35], v[44:47], v[84:87], v[32:35]
    v_xor_b32 v159, s61, v159
    s_waitcnt vmcnt(4)
    buffer_load_dwordx4 v[124:127], v159, s[48:51], 0 offen nt
    v_and_b32_dpp v40, v134, v8 row_newbcast:15 row_mask:0xf bank_mask:0xf
    v_and_b32_dpp v41, v134, v9 row_newbcast:15 row_mask:0xf bank_mask:0xf
    v_and_b32_dpp v42, v134, v10 row_newbcast:15 row_mask:0xf bank_mask:0xf
    v_and_b32_dpp v43, v134, v11 row_newbcast:15 row_mask:0xf bank_mask:0xf
    v_mov_b32_dpp v134, v134 row_shr:1 row_mask:0xf bank_mask:0xf
    s_nop 0
    v_mfma_f32_16x16x32_bf16 v[32:35], v[40:43], v[88:91], v[32:35]
    v_and_b32_dpp v44, v135, v8 row_newbcast:15 row_mask:0xf bank_mask:0xf
    v_and_b32_dpp v45, v135, v9 row_newbcast:15 row_mask:0xf bank_mask:0xf
    v_and_b32_dpp v46, v135, v10 row_newbcast:15 row_mask:0xf bank_mask:0xf
    v_and_b32_dpp v47, v135, v11 row_newbcast:15 row_mask:0xf bank_mask:0xf
    v_mov_b32_dpp v135, v135 row_shr:1 row_mask:0xf bank_mask:0xf
    s_nop 0
    v_mfma_f32_16x16x32_bf16 v[32:35], v[44:47], v[92:95], v[32:35]
    ds_read_b32 v60, v61 offset:1536
    s_waitcnt lgkmcnt(0)
    s_barrier
    s_mov_b32 s63, 18780
    s_waitcnt lgkmcnt(0)
    v_readfirstlane_b32 s10, v60
    s_cmp_eq_u32 s10, 0
    s_cbranch_scc1 L_bv0
    s_cmp_eq_u32 s10, 1
    s_cbranch_scc1 L_bv1
    s_cmp_eq_u32 s10, 2
    s_cbranch_scc1 L_bv2
    s_branch L_bv3
L_bv0:
    s_add_u32 s64, s64, 1
    v_readlane_b32 s61, v160, s64
    s_nop 1
    v_xor_b32 v152, s61, v152
    s_waitcnt vmcnt(3)
    buffer_load_dwordx4 v[64:67], v152, s[48:51], 0 offen nt
    v_and_b32_dpp v40, v136, v8 row_newbcast:15 row_mask:0xf bank_mask:0xf
    v_and_b32_dpp v41, v136, v9 row_newbcast:15 row_mask:0xf bank_mask:0xf
    v_and_b32_dpp v42, v136, v10 row_newbcast:15 row_mask:0xf bank_mask:0xf
    v_and_b32_dpp v43, v136, v11 row_newbcast:15 row_mask:0xf bank_mask:0xf
    v_mov_b32_dpp v136, v136 row_shr:1 row_mask:0xf bank_mask:0xf
    s_nop 0
    v_mfma_f32_16x16x32_bf16 v[32:35], v[40:43], v[96:99], v[32:35]
    v_xor_b32 v153, s61, v153
    s_waitcnt vmcnt(4)
    buffer_load_dwordx4 v[68:71], v153, s[48:51], 0 offen nt
    v_and_b32_dpp v44, v137, v8 row_newbcast:15 row_mask:0xf bank_mask:0xf
    v_and_b32_dpp v45, v137, v9 row_newbcast:15 row_mask:0xf bank_mask:0xf
    v_and_b32_dpp v46, v137, v10 row_newbcast:15 row_mask:0xf bank_mask:0xf
    v_and_b32_dpp v47, v137, v11 row_newbcast:15 row_mask:0xf bank_mask:0xf
    v_mov_b32_dpp v137, v137 row_shr:1 row_mask:0xf bank_mask:0xf
    s_nop 0
    v_mfma_f32_16x16x32_bf16 v[32:35], v[44:47], v[100:103], v[32:35]
    v_xor_b32 v154, s61, v154
    s_waitcnt vmcnt(4)
    buffer_load_dwordx4 v[72:75], v154, s[48:51], 0 offen nt
    v_and_b32_dpp v40, v138, v8 row_newbcast:15 row_mask:0xf bank_mask:0xf
    v_and_b32_dpp v41, v138, v9 row_newbcast:15 row_mask:0xf bank_mask:0xf
    v_and_b32_dpp v42, v138, v10 row_newbcast:15 row_mask:0xf bank_mask:0xf
    v_and_b32_dpp v43, v138, v11 row_newbcast:15 row_mask:0xf bank_mask:0xf
    v_mov_b32_dpp v138, v138 row_shr:1 row_mask:0xf bank_mask:0xf
    s_nop 0
    v_mfma_f32_16x16x32_bf16 v[32:35], v[40:43], v[104:107], v[32:35]
    v_xor_b32 v155, s61, v155
    s_waitcnt vmcnt(4)
    buffer_load_dwordx4 v[76:79], v155, s[48:51], 0 offen nt
    v_and_b32_dpp v44, v139, v8 row_newbcast:15 row_mask:0xf bank_mask:0xf
    v_and_b32_dpp v45, v139, v9 row_newbcast:15 row_mask:0xf bank_mask:0xf
    v_and_b32_dpp v46, v139, v10 row_newbcast:15 row_mask:0xf bank_mask:0xf
    v_and_b32_dpp v47, v139, v11 row_newbcast:15 row_mask:0xf bank_mask:0xf
    v_mov_b32_dpp v139, v139 row_shr:1 row_mask:0xf bank_mask:0xf
    s_nop 0
    v_mfma_f32_16x16x32_bf16 v[32:35], v[44:47], v[108:111], v[32:35]
    v_xor_b32 v156, s61, v156
    s_waitcnt vmcnt(4)
    buffer_load_dwordx4 v[80:83], v156, s[48:51], 0 offen nt
    v_and_b32_dpp v40, v140, v8 row_newbcast:15 row_mask:0xf bank_mask:0xf
    v_and_b32_dpp v41, v140, v9 row_newbcast:15 row_mask:0xf bank_mask:0xf
    v_and_b32_dpp v42, v140, v10 row_newbcast:15 row_mask:0xf bank_mask:0xf
    v_and_b32_dpp v43, v140, v11 row_newbcast:15 row_mask:0xf bank_mask:0xf
    v_mov_b32_dpp v140, v140 row_shr:1 row_mask:0xf bank_mask:0xf
    s_nop 0
    v_mfma_f32_16x16x32_bf16 v[32:35], v[40:43], v[112:115], v[32:35]
    v_xor_b32 v157, s61, v157
    s_waitcnt vmcnt(4)
    buffer_load_dwordx4 v[84:87], v157, s[48:51], 0 offen nt
    v_and_b32_dpp v44, v141, v8 row_newbcast:15 row_mask:0xf bank_mask:0xf
    v_and_b32_dpp v45, v141, v9 row_newbcast:15 row_mask:0xf bank_mask:0xf
    v_and_b32_dpp v46, v141, v10 row_newbcast:15 row_mask:0xf bank_mask:0xf
    v_and_b32_dpp v47, v141, v11 row_newbcast:15 row_mask:0xf bank_mask:0xf
    v_mov_b32_dpp v141, v141 row_shr:1 row_mask:0xf bank_mask:0xf
    s_nop 0
    v_mfma_f32_16x16x32_bf16 v[32:35], v[44:47], v[116:119], v[32:35]
    v_xor_b32 v158, s61, v158
    s_waitcnt vmcnt(4)
    buffer_load_dwordx4 v[88:91], v158, s[48:51], 0 offen nt
    v_and_b32_dpp v40, v142, v8 row_newbcast:15 row_mask:0xf bank_mask:0xf
    v_and_b32_dpp v41, v142, v9 row_newbcast:15 row_mask:0xf bank_mask:0xf
    v_and_b32_dpp v42, v142, v10 row_newbcast:15 row_mask:0xf bank_mask:0xf
    v_and_b32_dpp v43, v142, v11 row_newbcast:15 row_mask:0xf bank_mask:0xf
    v_mov_b32_dpp v142, v142 row_shr:1 row_mask:0xf bank_mask:0xf
    s_nop 0
    v_mfma_f32_16x16x32_bf16 v[32:35], v[40:43], v[120:123], v[32:35]
    v_xor_b32 v159, s61, v159
    s_waitcnt vmcnt(4)
    buffer_load_dwordx4 v[92:95], v159, s[48:51], 0 offen nt
    v_and_b32_dpp v44, v143, v8 row_newbcast:15 row_mask:0xf bank_mask:0xf
    v_and_b32_dpp v45, v143, v9 row_newbcast:15 row_mask:0xf bank_mask:0xf
    v_and_b32_dpp v46, v143, v10 row_newbcast:15 row_mask:0xf bank_mask:0xf
    v_and_b32_dpp v47, v143, v11 row_newbcast:15 row_mask:0xf bank_mask:0xf
    v_mov_b32_dpp v143, v143 row_shr:1 row_mask:0xf bank_mask:0xf
    s_nop 0
    v_mfma_f32_16x16x32_bf16 v[32:35], v[44:47], v[124:127], v[32:35]
    s_bitcmp1_b32 s63, s14
    s_cbranch_scc0 L_bvc0
    s_barrier
L_bvc0:
    s_add_u32 s64, s64, 1
    v_readlane_b32 s61, v160, s64
    s_nop 1
    v_xor_b32 v152, s61, v152
    s_waitcnt vmcnt(3)
    buffer_load_dwordx4 v[96:99], v152, s[48:51], 0 offen nt
    v_and_b32_dpp v40, v128, v8 row_newbcast:15 row_mask:0xf bank_mask:0xf
    v_and_b32_dpp v41, v128, v9 row_newbcast:15 row_mask:0xf bank_mask:0xf
    v_and_b32_dpp v42, v128, v10 row_newbcast:15 row_mask:0xf bank_mask:0xf
    v_and_b32_dpp v43, v128, v11 row_newbcast:15 row_mask:0xf bank_mask:0xf
    v_mov_b32_dpp v128, v128 row_shr:1 row_mask:0xf bank_mask:0xf
    s_nop 0
    v_mfma_f32_16x16x32_bf16 v[32:35], v[40:43], v[64:67], v[32:35]
    v_xor_b32 v153, s61, v153
    s_waitcnt vmcnt(4)
    buffer_load_dwordx4 v[100:103], v153, s[48:51], 0 offen nt
    v_and_b32_dpp v44, v129, v8 row_newbcast:15 row_mask:0xf bank_mask:0xf
    v_and_b32_dpp v45, v129, v9 row_newbcast:15 row_mask:0xf bank_mask:0xf
    v_and_b32_dpp v46, v129, v10 row_newbcast:15 row_mask:0xf bank_mask:0xf
    v_and_b32_dpp v47, v129, v11 row_newbcast:15 row_mask:0xf bank_mask:0xf
    v_mov_b32_dpp v129, v129 row_shr:1 row_mask:0xf bank_mask:0xf
    s_nop 0
    v_mfma_f32_16x16x32_bf16 v[32:35], v[44:47], v[68:71], v[32:35]
    v_xor_b32 v154, s61, v154
    s_waitcnt vmcnt(4)
    buffer_load_dwordx4 v[104:107], v154, s[48:51], 0 offen nt
    v_and_b32_dpp v40, v130, v8 row_newbcast:15 row_mask:0xf bank_mask:0xf
    v_and_b32_dpp v41, v130, v9 row_newbcast:15 row_mask:0xf bank_mask:0xf
    v_and_b32_dpp v42, v130, v10 row_newbcast:15 row_mask:0xf bank_mask:0xf
    v_and_b32_dpp v43, v130, v11 row_newbcast:15 row_mask:0xf bank_mask:0xf
    v_mov_b32_dpp v130, v130 row_shr:1 row_mask:0xf bank_mask:0xf
    s_nop 0
    v_mfma_f32_16x16x32_bf16 v[32:35], v[40:43], v[72:75], v[32:35]
    v_xor_b32 v155, s61, v155
    s_waitcnt vmcnt(4)
    buffer_load_dwordx4 v[108:111], v155, s[48:51], 0 offen nt
    v_and_b32_dpp v44, v131, v8 row_newbcast:15 row_mask:0xf bank_mask:0xf
    v_and_b32_dpp v45, v131, v9 row_newbcast:15 row_mask:0xf bank_mask:0xf
    v_and_b32_dpp v46, v131, v10 row_newbcast:15 row_mask:0xf bank_mask:0xf
    v_and_b32_dpp v47, v131, v11 row_newbcast:15 row_mask:0xf bank_mask:0xf
    v_mov_b32_dpp v131, v131 row_shr:1 row_mask:0xf bank_mask:0xf
    s_nop 0
    v_mfma_f32_16x16x32_bf16 v[32:35], v[44:47], v[76:79], v[32:35]
    v_xor_b32 v156, s61, v156
    s_waitcnt vmcnt(4)
    buffer_load_dwordx4 v[112:115], v156, s[48:51], 0 offen nt
    v_and_b32_dpp v40, v132, v8 row_newbcast:15 row_mask:0xf bank_mask:0xf
    v_and_b32_dpp v41, v132, v9 row_newbcast:15 row_mask:0xf bank_mask:0xf
    v_and_b32_dpp v42, v132, v10 row_newbcast:15 row_mask:0xf bank_mask:0xf
    v_and_b32_dpp v43, v132, v11 row_newbcast:15 row_mask:0xf bank_mask:0xf
    v_mov_b32_dpp v132, v132 row_shr:1 row_mask:0xf bank_mask:0xf
    s_nop 0
    v_mfma_f32_16x16x32_bf16 v[32:35], v[40:43], v[80:83], v[32:35]
    v_xor_b32 v157, s61, v157
    s_waitcnt vmcnt(4)
    buffer_load_dwordx4 v[116:119], v157, s[48:51], 0 offen nt
    v_and_b32_dpp v44, v133, v8 row_newbcast:15 row_mask:0xf bank_mask:0xf
    v_and_b32_dpp v45, v133, v9 row_newbcast:15 row_mask:0xf bank_mask:0xf
    v_and_b32_dpp v46, v133, v10 row_newbcast:15 row_mask:0xf bank_mask:0xf
    v_and_b32_dpp v47, v133, v11 row_newbcast:15 row_mask:0xf bank_mask:0xf
    v_mov_b32_dpp v133, v133 row_shr:1 row_mask:0xf bank_mask:0xf
    s_nop 0
    v_mfma_f32_16x16x32_bf16 v[32:35], v[44:47], v[84:87], v[32:35]
    v_xor_b32 v158, s61, v158
    s_waitcnt vmcnt(4)
    buffer_load_dwordx4 v[120:123], v158, s[48:51], 0 offen nt
    v_and_b32_dpp v40, v134, v8 row_newbcast:15 row_mask:0xf bank_mask:0xf
    v_and_b32_dpp v41, v134, v9 row_newbcast:15 row_mask:0xf bank_mask:0xf
    v_and_b32_dpp v42, v134, v10 row_newbcast:15 row_mask:0xf bank_mask:0xf
    v_and_b32_dpp v43, v134, v11 row_newbcast:15 row_mask:0xf bank_mask:0xf
    v_mov_b32_dpp v134, v134 row_shr:1 row_mask:0xf bank_mask:0xf
    s_nop 0
    v_mfma_f32_16x16x32_bf16 v[32:35], v[40:43], v[88:91], v[32:35]
    v_xor_b32 v159, s61, v159
    s_waitcnt vmcnt(4)
    buffer_load_dwordx4 v[124:127], v159, s[48:51], 0 offen nt
    v_and_b32_dpp v44, v135, v8 row_newbcast:15 row_mask:0xf bank_mask:0xf
    v_and_b32_dpp v45, v135, v9 row_newbcast:15 row_mask:0xf bank_mask:0xf
    v_and_b32_dpp v46, v135, v10 row_newbcast:15 row_mask:0xf bank_mask:0xf
    v_and_b32_dpp v47, v135, v11 row_newbcast:15 row_mask:0xf bank_mask:0xf
    v_mov_b32_dpp v135, v135 row_shr:1 row_mask:0xf bank_mask:0xf
    s_nop 0
    v_mfma_f32_16x16x32_bf16 v[32:35], v[44:47], v[92:95], v[32:35]
    ds_read_b32 v60, v61 offset:1536
    s_sub_u32 s14, s14, 1
    s_cmp_eq_u32 s14, 0
    s_cbranch_scc1 L_bvend
    s_waitcnt lgkmcnt(0)
    v_readfirstlane_b32 s10, v60
    s_cmp_eq_u32 s10, 0
    s_cbranch_scc1 L_bv0
    s_cmp_eq_u32 s10, 1
    s_cbranch_scc1 L_bv1
    s_cmp_eq_u32 s10, 2
    s_cbranch_scc1 L_bv2
    s_branch L_bv3
L_bv1:
    s_add_u32 s64, s64, 1
    v_readlane_b32 s61, v160, s64
    s_nop 1
    v_xor_b32 v152, s61, v152
    s_waitcnt vmcnt(4)
    buffer_load_dwordx4 v[64:67], v152, s[48:51], 0 offen nt
    v_and_b32_dpp v40, v136, v8 row_newbcast:15 row_mask:0xf bank_mask:0xf
    v_and_b32_dpp v41, v136, v9 row_newbcast:15 row_mask:0xf bank_mask:0xf
    v_and_b32_dpp v42, v136, v10 row_newbcast:15 row_mask:0xf bank_mask:0xf
    v_and_b32_dpp v43, v136, v11 row_newbcast:15 row_mask:0xf bank_mask:0xf
    v_mov_b32_dpp v136, v136 row_shr:1 row_mask:0xf bank_mask:0xf
    s_nop 0
    v_mfma_f32_16x16x32_bf16 v[32:35], v[40:43], v[96:99], v[32:35]
    v_xor_b32 v153, s61, v153
    s_waitcnt vmcnt(5)
    buffer_load_dwordx4 v[68:71], v153, s[48:51], 0 offen nt
    v_and_b32_dpp v44, v137, v8 row_newbcast:15 row_mask:0xf bank_mask:0xf
    v_and_b32_dpp v45, v137, v9 row_newbcast:15 row_mask:0xf bank_mask:0xf
    v_and_b32_dpp v46, v137, v10 row_newbcast:15 row_mask:0xf bank_mask:0xf
    v_and_b32_dpp v47, v137, v11 row_newbcast:15 row_mask:0xf bank_mask:0xf
    v_mov_b32_dpp v137, v137 row_shr:1 row_mask:0xf bank_mask:0xf
    s_nop 0
    v_mfma_f32_16x16x32_bf16 v[32:35], v[44:47], v[100:103], v[32:35]
    v_xor_b32 v154, s61, v154
    s_waitcnt vmcnt(4)
    buffer_load_dwordx4 v[72:75], v154, s[48:51], 0 offen nt
    v_and_b32_dpp v40, v138, v8 row_newbcast:15 row_mask:0xf bank_mask:0xf
    v_and_b32_dpp v41, v138, v9 row_newbcast:15 row_mask:0xf bank_mask:0xf
    v_and_b32_dpp v42, v138, v10 row_newbcast:15 row_mask:0xf bank_mask:0xf
    v_and_b32_dpp v43, v138, v11 row_newbcast:15 row_mask:0xf bank_mask:0xf
    v_mov_b32_dpp v138, v138 row_shr:1 row_mask:0xf bank_mask:0xf
    s_nop 0
    v_mfma_f32_16x16x32_bf16 v[32:35], v[40:43], v[104:107], v[32:35]
    v_xor_b32 v155, s61, v155
    s_waitcnt vmcnt(5)
    buffer_load_dwordx4 v[76:79], v155, s[48:51], 0 offen nt
    v_and_b32_dpp v44, v139, v8 row_newbcast:15 row_mask:0xf bank_mask:0xf
    v_and_b32_dpp v45, v139, v9 row_newbcast:15 row_mask:0xf bank_mask:0xf
    v_and_b32_dpp v46, v139, v10 row_newbcast:15 row_mask:0xf bank_mask:0xf
    v_and_b32_dpp v47, v139, v11 row_newbcast:15 row_mask:0xf bank_mask:0xf
    v_mov_b32_dpp v139, v139 row_shr:1 row_mask:0xf bank_mask:0xf
    s_nop 0
    v_mfma_f32_16x16x32_bf16 v[32:35], v[44:47], v[108:111], v[32:35]
    v_xor_b32 v156, s61, v156
    s_waitcnt vmcnt(4)
    buffer_load_dwordx4 v[80:83], v156, s[48:51], 0 offen nt
    v_and_b32_dpp v40, v140, v8 row_newbcast:15 row_mask:0xf bank_mask:0xf
    v_and_b32_dpp v41, v140, v9 row_newbcast:15 row_mask:0xf bank_mask:0xf
    v_and_b32_dpp v42, v140, v10 row_newbcast:15 row_mask:0xf bank_mask:0xf
    v_and_b32_dpp v43, v140, v11 row_newbcast:15 row_mask:0xf bank_mask:0xf
    v_mov_b32_dpp v140, v140 row_shr:1 row_mask:0xf bank_mask:0xf
    s_nop 0
    v_mfma_f32_16x16x32_bf16 v[32:35], v[40:43], v[112:115], v[32:35]
    v_xor_b32 v157, s61, v157
    s_waitcnt vmcnt(5)
    buffer_load_dwordx4 v[84:87], v157, s[48:51], 0 offen nt
    v_and_b32_dpp v44, v141, v8 row_newbcast:15 row_mask:0xf bank_mask:0xf
    v_and_b32_dpp v45, v141, v9 row_newbcast:15 row_mask:0xf bank_mask:0xf
    v_and_b32_dpp v46, v141, v10 row_newbcast:15 row_mask:0xf bank_mask:0xf
    v_and_b32_dpp v47, v141, v11 row_newbcast:15 row_mask:0xf bank_mask:0xf
    v_mov_b32_dpp v141, v141 row_shr:1 row_mask:0xf bank_mask:0xf
    s_nop 0
    v_mfma_f32_16x16x32_bf16 v[32:35], v[44:47], v[116:119], v[32:35]
    v_xor_b32 v158, s61, v158
    s_waitcnt vmcnt(4)
    buffer_load_dwordx4 v[88:91], v158, s[48:51], 0 offen nt
    v_and_b32_dpp v40, v142, v8 row_newbcast:15 row_mask:0xf bank_mask:0xf
    v_and_b32_dpp v41, v142, v9 row_newbcast:15 row_mask:0xf bank_mask:0xf
    v_and_b32_dpp v42, v142, v10 row_newbcast:15 row_mask:0xf bank_mask:0xf
    v_and_b32_dpp v43, v142, v11 row_newbcast:15 row_mask:0xf bank_mask:0xf
    v_mov_b32_dpp v142, v142 row_shr:1 row_mask:0xf bank_mask:0xf
    s_nop 0
    v_mfma_f32_16x16x32_bf16 v[32:35], v[40:43], v[120:123], v[32:35]
    v_xor_b32 v159, s61, v159
    s_waitcnt vmcnt(5)
    buffer_load_dwordx4 v[92:95], v159, s[48:51], 0 offen nt
    v_and_b32_dpp v44, v143, v8 row_newbcast:15 row_mask:0xf bank_mask:0xf
    v_and_b32_dpp v45, v143, v9 row_newbcast:15 row_mask:0xf bank_mask:0xf
    v_and_b32_dpp v46, v143, v10 row_newbcast:15 row_mask:0xf bank_mask:0xf
    v_and_b32_dpp v47, v143, v11 row_newbcast:15 row_mask:0xf bank_mask:0xf
    v_mov_b32_dpp v143, v143 row_shr:1 row_mask:0xf bank_mask:0xf
    s_nop 0
    v_mfma_f32_16x16x32_bf16 v[32:35], v[44:47], v[124:127], v[32:35]
    s_bitcmp1_b32 s63, s14
    s_cbranch_scc0 L_bvc1
    s_barrier
L_bvc1:
    s_add_u32 s64, s64, 1
    v_readlane_b32 s61, v160, s64
    s_nop 1
    v_xor_b32 v152, s61, v152
    s_waitcnt vmcnt(4)
    buffer_load_dwordx4 v[96:99], v152, s[48:51], 0 offen nt
    v_and_b32_dpp v40, v128, v8 row_newbcast:15 row_mask:0xf bank_mask:0xf
    v_and_b32_dpp v41, v128, v9 row_newbcast:15 row_mask:0xf bank_mask:0xf
    v_and_b32_dpp v42, v128, v10 row_newbcast:15 row_mask:0xf bank_mask:0xf
    v_and_b32_dpp v43, v128, v11 row_newbcast:15 row_mask:0xf bank_mask:0xf
    v_mov_b32_dpp v128, v128 row_shr:1 row_mask:0xf bank_mask:0xf
    s_nop 0
    v_mfma_f32_16x16x32_bf16 v[32:35], v[40:43], v[64:67], v[32:35]
    v_xor_b32 v153, s61, v153
    s_waitcnt vmcnt(5)
    buffer_load_dwordx4 v[100:103], v153, s[48:51], 0 offen nt
    v_and_b32_dpp v44, v129, v8 row_newbcast:15 row_mask:0xf bank_mask:0xf
    v_and_b32_dpp v45, v129, v9 row_newbcast:15 row_mask:0xf bank_mask:0xf
    v_and_b32_dpp v46, v129, v10 row_newbcast:15 row_mask:0xf bank_mask:0xf
    v_and_b32_dpp v47, v129, v11 row_newbcast:15 row_mask:0xf bank_mask:0xf
    v_mov_b32_dpp v129, v129 row_shr:1 row_mask:0xf bank_mask:0xf
    s_nop 0
    v_mfma_f32_16x16x32_bf16 v[32:35], v[44:47], v[68:71], v[32:35]
    v_xor_b32 v154, s61, v154
    s_waitcnt vmcnt(4)
    buffer_load_dwordx4 v[104:107], v154, s[48:51], 0 offen nt
    v_and_b32_dpp v40, v130, v8 row_newbcast:15 row_mask:0xf bank_mask:0xf
    v_and_b32_dpp v41, v130, v9 row_newbcast:15 row_mask:0xf bank_mask:0xf
    v_and_b32_dpp v42, v130, v10 row_newbcast:15 row_mask:0xf bank_mask:0xf
    v_and_b32_dpp v43, v130, v11 row_newbcast:15 row_mask:0xf bank_mask:0xf
    v_mov_b32_dpp v130, v130 row_shr:1 row_mask:0xf bank_mask:0xf
    s_nop 0
    v_mfma_f32_16x16x32_bf16 v[32:35], v[40:43], v[72:75], v[32:35]
    v_xor_b32 v155, s61, v155
    s_waitcnt vmcnt(5)
    buffer_load_dwordx4 v[108:111], v155, s[48:51], 0 offen nt
    v_and_b32_dpp v44, v131, v8 row_newbcast:15 row_mask:0xf bank_mask:0xf
    v_and_b32_dpp v45, v131, v9 row_newbcast:15 row_mask:0xf bank_mask:0xf
    v_and_b32_dpp v46, v131, v10 row_newbcast:15 row_mask:0xf bank_mask:0xf
    v_and_b32_dpp v47, v131, v11 row_newbcast:15 row_mask:0xf bank_mask:0xf
    v_mov_b32_dpp v131, v131 row_shr:1 row_mask:0xf bank_mask:0xf
    s_nop 0
    v_mfma_f32_16x16x32_bf16 v[32:35], v[44:47], v[76:79], v[32:35]
    v_xor_b32 v156, s61, v156
    s_waitcnt vmcnt(4)
    buffer_load_dwordx4 v[112:115], v156, s[48:51], 0 offen nt
    v_and_b32_dpp v40, v132, v8 row_newbcast:15 row_mask:0xf bank_mask:0xf
    v_and_b32_dpp v41, v132, v9 row_newbcast:15 row_mask:0xf bank_mask:0xf
    v_and_b32_dpp v42, v132, v10 row_newbcast:15 row_mask:0xf bank_mask:0xf
    v_and_b32_dpp v43, v132, v11 row_newbcast:15 row_mask:0xf bank_mask:0xf
    v_mov_b32_dpp v132, v132 row_shr:1 row_mask:0xf bank_mask:0xf
    s_nop 0
    v_mfma_f32_16x16x32_bf16 v[32:35], v[40:43], v[80:83], v[32:35]
    v_xor_b32 v157, s61, v157
    s_waitcnt vmcnt(5)
    buffer_load_dwordx4 v[116:119], v157, s[48:51], 0 offen nt
    v_and_b32_dpp v44, v133, v8 row_newbcast:15 row_mask:0xf bank_mask:0xf
    v_and_b32_dpp v45, v133, v9 row_newbcast:15 row_mask:0xf bank_mask:0xf
    v_and_b32_dpp v46, v133, v10 row_newbcast:15 row_mask:0xf bank_mask:0xf
    v_and_b32_dpp v47, v133, v11 row_newbcast:15 row_mask:0xf bank_mask:0xf
    v_mov_b32_dpp v133, v133 row_shr:1 row_mask:0xf bank_mask:0xf
    s_nop 0
    v_mfma_f32_16x16x32_bf16 v[32:35], v[44:47], v[84:87], v[32:35]
    v_xor_b32 v158, s61, v158
    s_waitcnt vmcnt(4)
    buffer_load_dwordx4 v[120:123], v158, s[48:51], 0 offen nt
    v_and_b32_dpp v40, v134, v8 row_newbcast:15 row_mask:0xf bank_mask:0xf
    v_and_b32_dpp v41, v134, v9 row_newbcast:15 row_mask:0xf bank_mask:0xf
    v_and_b32_dpp v42, v134, v10 row_newbcast:15 row_mask:0xf bank_mask:0xf
    v_and_b32_dpp v43, v134, v11 row_newbcast:15 row_mask:0xf bank_mask:0xf
    v_mov_b32_dpp v134, v134 row_shr:1 row_mask:0xf bank_mask:0xf
    s_nop 0
    v_mfma_f32_16x16x32_bf16 v[32:35], v[40:43], v[88:91], v[32:35]
    v_xor_b32 v159, s61, v159
    s_waitcnt vmcnt(5)
    buffer_load_dwordx4 v[124:127], v159, s[48:51], 0 offen nt
    v_and_b32_dpp v44, v135, v8 row_newbcast:15 row_mask:0xf bank_mask:0xf
    v_and_b32_dpp v45, v135, v9 row_newbcast:15 row_mask:0xf bank_mask:0xf
    v_and_b32_dpp v46, v135, v10 row_newbcast:15 row_mask:0xf bank_mask:0xf
    v_and_b32_dpp v47, v135, v11 row_newbcast:15 row_mask:0xf bank_mask:0xf
    v_mov_b32_dpp v135, v135 row_shr:1 row_mask:0xf bank_mask:0xf
    s_nop 0
    v_mfma_f32_16x16x32_bf16 v[32:35], v[44:47], v[92:95], v[32:35]
    ds_read_b32 v60, v61 offset:1536
    s_sub_u32 s14, s14, 1
    s_cmp_eq_u32 s14, 0
    s_cbranch_scc1 L_bvend
    s_waitcnt lgkmcnt(0)
    v_readfirstlane_b32 s10, v60
    s_cmp_eq_u32 s10, 0
    s_cbranch_scc1 L_bv0
    s_cmp_eq_u32 s10, 1
    s_cbranch_scc1 L_bv1
    s_cmp_eq_u32 s10, 2
    s_cbranch_scc1 L_bv2
    s_branch L_bv3
L_bv2:
    s_add_u32 s64, s64, 1
    v_readlane_b32 s61, v160, s64
    s_nop 1
    v_xor_b32 v152, s61, v152
    s_waitcnt vmcnt(5)
    buffer_load_dwordx4 v[64:67], v152, s[48:51], 0 offen nt
    v_and_b32_dpp v40, v136, v8 row_newbcast:15 row_mask:0xf bank_mask:0xf
    v_and_b32_dpp v41, v136, v9 row_newbcast:15 row_mask:0xf bank_mask:0xf
    v_and_b32_dpp v42, v136, v10 row_newbcast:15 row_mask:0xf bank_mask:0xf
    v_and_b32_dpp v43, v136, v11 row_newbcast:15 row_mask:0xf bank_mask:0xf
    v_mov_b32_dpp v136, v136 row_shr:1 row_mask:0xf bank_mask:0xf
    s_nop 0
    v_mfma_f32_16x16x32_bf16 v[32:35], v[40:43], v[96:99], v[32:35]
    v_xor_b32 v153, s61, v153
    s_waitcnt vmcnt(5)
    buffer_load_dwordx4 v[68:71], v153, s[48:51], 0 offen nt
    v_and_b32_dpp v44, v137, v8 row_newbcast:15 row_mask:0xf bank_mask:0xf
    v_and_b32_dpp v45, v137, v9 row_newbcast:15 row_mask:0xf bank_mask:0xf
    v_and_b32_dpp v46, v137, v10 row_newbcast:15 row_mask:0xf bank_mask:0xf
    v_and_b32_dpp v47, v137, v11 row_newbcast:15 row_mask:0xf bank_mask:0xf
    v_mov_b32_dpp v137, v137 row_shr:1 row_mask:0xf bank_mask:0xf
    s_nop 0
    v_mfma_f32_16x16x32_bf16 v[32:35], v[44:47], v[100:103], v[32:35]
    v_xor_b32 v154, s61, v154
    s_waitcnt vmcnt(5)
    buffer_load_dwordx4 v[72:75], v154, s[48:51], 0 offen nt
    v_and_b32_dpp v40, v138, v8 row_newbcast:15 row_mask:0xf bank_mask:0xf
    v_and_b32_dpp v41, v138, v9 row_newbcast:15 row_mask:0xf bank_mask:0xf
    v_and_b32_dpp v42, v138, v10 row_newbcast:15 row_mask:0xf bank_mask:0xf
    v_and_b32_dpp v43, v138, v11 row_newbcast:15 row_mask:0xf bank_mask:0xf
    v_mov_b32_dpp v138, v138 row_shr:1 row_mask:0xf bank_mask:0xf
    s_nop 0
    v_mfma_f32_16x16x32_bf16 v[32:35], v[40:43], v[104:107], v[32:35]
    v_xor_b32 v155, s61, v155
    s_waitcnt vmcnt(5)
    buffer_load_dwordx4 v[76:79], v155, s[48:51], 0 offen nt
    v_and_b32_dpp v44, v139, v8 row_newbcast:15 row_mask:0xf bank_mask:0xf
    v_and_b32_dpp v45, v139, v9 row_newbcast:15 row_mask:0xf bank_mask:0xf
    v_and_b32_dpp v46, v139, v10 row_newbcast:15 row_mask:0xf bank_mask:0xf
    v_and_b32_dpp v47, v139, v11 row_newbcast:15 row_mask:0xf bank_mask:0xf
    v_mov_b32_dpp v139, v139 row_shr:1 row_mask:0xf bank_mask:0xf
    s_nop 0
    v_mfma_f32_16x16x32_bf16 v[32:35], v[44:47], v[108:111], v[32:35]
    v_xor_b32 v156, s61, v156
    s_waitcnt vmcnt(5)
    buffer_load_dwordx4 v[80:83], v156, s[48:51], 0 offen nt
    v_and_b32_dpp v40, v140, v8 row_newbcast:15 row_mask:0xf bank_mask:0xf
    v_and_b32_dpp v41, v140, v9 row_newbcast:15 row_mask:0xf bank_mask:0xf
    v_and_b32_dpp v42, v140, v10 row_newbcast:15 row_mask:0xf bank_mask:0xf
    v_and_b32_dpp v43, v140, v11 row_newbcast:15 row_mask:0xf bank_mask:0xf
    v_mov_b32_dpp v140, v140 row_shr:1 row_mask:0xf bank_mask:0xf
    s_nop 0
    v_mfma_f32_16x16x32_bf16 v[32:35], v[40:43], v[112:115], v[32:35]
    v_xor_b32 v157, s61, v157
    s_waitcnt vmcnt(5)
    buffer_load_dwordx4 v[84:87], v157, s[48:51], 0 offen nt
    v_and_b32_dpp v44, v141, v8 row_newbcast:15 row_mask:0xf bank_mask:0xf
    v_and_b32_dpp v45, v141, v9 row_newbcast:15 row_mask:0xf bank_mask:0xf
    v_and_b32_dpp v46, v141, v10 row_newbcast:15 row_mask:0xf bank_mask:0xf
    v_and_b32_dpp v47, v141, v11 row_newbcast:15 row_mask:0xf bank_mask:0xf
    v_mov_b32_dpp v141, v141 row_shr:1 row_mask:0xf bank_mask:0xf
    s_nop 0
    v_mfma_f32_16x16x32_bf16 v[32:35], v[44:47], v[116:119], v[32:35]
    v_xor_b32 v158, s61, v158
    s_waitcnt vmcnt(5)
    buffer_load_dwordx4 v[88:91], v158, s[48:51], 0 offen nt
    v_and_b32_dpp v40, v142, v8 row_newbcast:15 row_mask:0xf bank_mask:0xf
    v_and_b32_dpp v41, v142, v9 row_newbcast:15 row_mask:0xf bank_mask:0xf
    v_and_b32_dpp v42, v142, v10 row_newbcast:15 row_mask:0xf bank_mask:0xf
    v_and_b32_dpp v43, v142, v11 row_newbcast:15 row_mask:0xf bank_mask:0xf
    v_mov_b32_dpp v142, v142 row_shr:1 row_mask:0xf bank_mask:0xf
    s_nop 0
    v_mfma_f32_16x16x32_bf16 v[32:35], v[40:43], v[120:123], v[32:35]
    v_xor_b32 v159, s61, v159
    s_waitcnt vmcnt(5)
    buffer_load_dwordx4 v[92:95], v159, s[48:51], 0 offen nt
    v_and_b32_dpp v44, v143, v8 row_newbcast:15 row_mask:0xf bank_mask:0xf
    v_and_b32_dpp v45, v143, v9 row_newbcast:15 row_mask:0xf bank_mask:0xf
    v_and_b32_dpp v46, v143, v10 row_newbcast:15 row_mask:0xf bank_mask:0xf
    v_and_b32_dpp v47, v143, v11 row_newbcast:15 row_mask:0xf bank_mask:0xf
    v_mov_b32_dpp v143, v143 row_shr:1 row_mask:0xf bank_mask:0xf
    s_nop 0
    v_mfma_f32_16x16x32_bf16 v[32:35], v[44:47], v[124:127], v[32:35]
    s_bitcmp1_b32 s63, s14
    s_cbranch_scc0 L_bvc2
    s_barrier
L_bvc2:
    s_add_u32 s64, s64, 1
    v_readlane_b32 s61, v160, s64
    s_nop 1
    v_xor_b32 v152, s61, v152
    s_waitcnt vmcnt(5)
    buffer_load_dwordx4 v[96:99], v152, s[48:51], 0 offen nt
    v_and_b32_dpp v40, v128, v8 row_newbcast:15 row_mask:0xf bank_mask:0xf
    v_and_b32_dpp v41, v128, v9 row_newbcast:15 row_mask:0xf bank_mask:0xf
    v_and_b32_dpp v42, v128, v10 row_newbcast:15 row_mask:0xf bank_mask:0xf
    v_and_b32_dpp v43, v128, v11 row_newbcast:15 row_mask:0xf bank_mask:0xf
    v_mov_b32_dpp v128, v128 row_shr:1 row_mask:0xf bank_mask:0xf
    s_nop 0
    v_mfma_f32_16x16x32_bf16 v[32:35], v[40:43], v[64:67], v[32:35]
    v_xor_b32 v153, s61, v153
    s_waitcnt vmcnt(5)
    buffer_load_dwordx4 v[100:103], v153, s[48:51], 0 offen nt
    v_and_b32_dpp v44, v129, v8 row_newbcast:15 row_mask:0xf bank_mask:0xf
    v_and_b32_dpp v45, v129, v9 row_newbcast:15 row_mask:0xf bank_mask:0xf
    v_and_b32_dpp v46, v129, v10 row_newbcast:15 row_mask:0xf bank_mask:0xf
    v_and_b32_dpp v47, v129, v11 row_newbcast:15 row_mask:0xf bank_mask:0xf
    v_mov_b32_dpp v129, v129 row_shr:1 row_mask:0xf bank_mask:0xf
    s_nop 0
    v_mfma_f32_16x16x32_bf16 v[32:35], v[44:47], v[68:71], v[32:35]
    v_xor_b32 v154, s61, v154
    s_waitcnt vmcnt(5)
    buffer_load_dwordx4 v[104:107], v154, s[48:51], 0 offen nt
    v_and_b32_dpp v40, v130, v8 row_newbcast:15 row_mask:0xf bank_mask:0xf
    v_and_b32_dpp v41, v130, v9 row_newbcast:15 row_mask:0xf bank_mask:0xf
    v_and_b32_dpp v42, v130, v10 row_newbcast:15 row_mask:0xf bank_mask:0xf
    v_and_b32_dpp v43, v130, v11 row_newbcast:15 row_mask:0xf bank_mask:0xf
    v_mov_b32_dpp v130, v130 row_shr:1 row_mask:0xf bank_mask:0xf
    s_nop 0
    v_mfma_f32_16x16x32_bf16 v[32:35], v[40:43], v[72:75], v[32:35]
    v_xor_b32 v155, s61, v155
    s_waitcnt vmcnt(5)
    buffer_load_dwordx4 v[108:111], v155, s[48:51], 0 offen nt
    v_and_b32_dpp v44, v131, v8 row_newbcast:15 row_mask:0xf bank_mask:0xf
    v_and_b32_dpp v45, v131, v9 row_newbcast:15 row_mask:0xf bank_mask:0xf
    v_and_b32_dpp v46, v131, v10 row_newbcast:15 row_mask:0xf bank_mask:0xf
    v_and_b32_dpp v47, v131, v11 row_newbcast:15 row_mask:0xf bank_mask:0xf
    v_mov_b32_dpp v131, v131 row_shr:1 row_mask:0xf bank_mask:0xf
    s_nop 0
    v_mfma_f32_16x16x32_bf16 v[32:35], v[44:47], v[76:79], v[32:35]
    v_xor_b32 v156, s61, v156
    s_waitcnt vmcnt(5)
    buffer_load_dwordx4 v[112:115], v156, s[48:51], 0 offen nt
    v_and_b32_dpp v40, v132, v8 row_newbcast:15 row_mask:0xf bank_mask:0xf
    v_and_b32_dpp v41, v132, v9 row_newbcast:15 row_mask:0xf bank_mask:0xf
    v_and_b32_dpp v42, v132, v10 row_newbcast:15 row_mask:0xf bank_mask:0xf
    v_and_b32_dpp v43, v132, v11 row_newbcast:15 row_mask:0xf bank_mask:0xf
    v_mov_b32_dpp v132, v132 row_shr:1 row_mask:0xf bank_mask:0xf
    s_nop 0
    v_mfma_f32_16x16x32_bf16 v[32:35], v[40:43], v[80:83], v[32:35]
    v_xor_b32 v157, s61, v157
    s_waitcnt vmcnt(5)
    buffer_load_dwordx4 v[116:119], v157, s[48:51], 0 offen nt
    v_and_b32_dpp v44, v133, v8 row_newbcast:15 row_mask:0xf bank_mask:0xf
    v_and_b32_dpp v45, v133, v9 row_newbcast:15 row_mask:0xf bank_mask:0xf
    v_and_b32_dpp v46, v133, v10 row_newbcast:15 row_mask:0xf bank_mask:0xf
    v_and_b32_dpp v47, v133, v11 row_newbcast:15 row_mask:0xf bank_mask:0xf
    v_mov_b32_dpp v133, v133 row_shr:1 row_mask:0xf bank_mask:0xf
    s_nop 0
    v_mfma_f32_16x16x32_bf16 v[32:35], v[44:47], v[84:87], v[32:35]
    v_xor_b32 v158, s61, v158
    s_waitcnt vmcnt(5)
    buffer_load_dwordx4 v[120:123], v158, s[48:51], 0 offen nt
    v_and_b32_dpp v40, v134, v8 row_newbcast:15 row_mask:0xf bank_mask:0xf
    v_and_b32_dpp v41, v134, v9 row_newbcast:15 row_mask:0xf bank_mask:0xf
    v_and_b32_dpp v42, v134, v10 row_newbcast:15 row_mask:0xf bank_mask:0xf
    v_and_b32_dpp v43, v134, v11 row_newbcast:15 row_mask:0xf bank_mask:0xf
    v_mov_b32_dpp v134, v134 row_shr:1 row_mask:0xf bank_mask:0xf
    s_nop 0
    v_mfma_f32_16x16x32_bf16 v[32:35], v[40:43], v[88:91], v[32:35]
    v_xor_b32 v159, s61, v159
    s_waitcnt vmcnt(5)
    buffer_load_dwordx4 v[124:127], v159, s[48:51], 0 offen nt
    v_and_b32_dpp v44, v135, v8 row_newbcast:15 row_mask:0xf bank_mask:0xf
    v_and_b32_dpp v45, v135, v9 row_newbcast:15 row_mask:0xf bank_mask:0xf
    v_and_b32_dpp v46, v135, v10 row_newbcast:15 row_mask:0xf bank_mask:0xf
    v_and_b32_dpp v47, v135, v11 row_newbcast:15 row_mask:0xf bank_mask:0xf
    v_mov_b32_dpp v135, v135 row_shr:1 row_mask:0xf bank_mask:0xf
    s_nop 0
    v_mfma_f32_16x16x32_bf16 v[32:35], v[44:47], v[92:95], v[32:35]
    ds_read_b32 v60, v61 offset:1536
    s_sub_u32 s14, s14, 1
    s_cmp_eq_u32 s14, 0
    s_cbranch_scc1 L_bvend
    s_waitcnt lgkmcnt(0)
    v_readfirstlane_b32 s10, v60
    s_cmp_eq_u32 s10, 0
    s_cbranch_scc1 L_bv0
    s_cmp_eq_u32 s10, 1
    s_cbranch_scc1 L_bv1
    s_cmp_eq_u32 s10, 2
    s_cbranch_scc1 L_bv2
    s_branch L_bv3
L_bv3:
    s_add_u32 s64, s64, 1
    v_readlane_b32 s61, v160, s64
    s_nop 1
    v_xor_b32 v152, s61, v152
    s_waitcnt vmcnt(6)
    buffer_load_dwordx4 v[64:67], v152, s[48:51], 0 offen nt
    v_and_b32_dpp v40, v136, v8 row_newbcast:15 row_mask:0xf bank_mask:0xf
    v_and_b32_dpp v41, v136, v9 row_newbcast:15 row_mask:0xf bank_mask:0xf
    v_and_b32_dpp v42, v136, v10 row_newbcast:15 row_mask:0xf bank_mask:0xf
    v_and_b32_dpp v43, v136, v11 row_newbcast:15 row_mask:0xf bank_mask:0xf
    v_mov_b32_dpp v136, v136 row_shr:1 row_mask:0xf bank_mask:0xf
    s_nop 0
    v_mfma_f32_16x16x32_bf16 v[32:35], v[40:43], v[96:99], v[32:35]
    v_xor_b32 v153, s61, v153
    s_waitcnt vmcnt(6)
    buffer_load_dwordx4 v[68:71], v153, s[48:51], 0 offen nt
    v_and_b32_dpp v44, v137, v8 row_newbcast:15 row_mask:0xf bank_mask:0xf
    v_and_b32_dpp v45, v137, v9 row_newbcast:15 row_mask:0xf bank_mask:0xf
    v_and_b32_dpp v46, v137, v10 row_newbcast:15 row_mask:0xf bank_mask:0xf
    v_and_b32_dpp v47, v137, v11 row_newbcast:15 row_mask:0xf bank_mask:0xf
    v_mov_b32_dpp v137, v137 row_shr:1 row_mask:0xf bank_mask:0xf
    s_nop 0
    v_mfma_f32_16x16x32_bf16 v[32:35], v[44:47], v[100:103], v[32:35]
    v_xor_b32 v154, s61, v154
    s_waitcnt vmcnt(6)
    buffer_load_dwordx4 v[72:75], v154, s[48:51], 0 offen nt
    v_and_b32_dpp v40, v138, v8 row_newbcast:15 row_mask:0xf bank_mask:0xf
    v_and_b32_dpp v41, v138, v9 row_newbcast:15 row_mask:0xf bank_mask:0xf
    v_and_b32_dpp v42, v138, v10 row_newbcast:15 row_mask:0xf bank_mask:0xf
    v_and_b32_dpp v43, v138, v11 row_newbcast:15 row_mask:0xf bank_mask:0xf
    v_mov_b32_dpp v138, v138 row_shr:1 row_mask:0xf bank_mask:0xf
    s_nop 0
    v_mfma_f32_16x16x32_bf16 v[32:35], v[40:43], v[104:107], v[32:35]
    v_xor_b32 v155, s61, v155
    s_waitcnt vmcnt(6)
    buffer_load_dwordx4 v[76:79], v155, s[48:51], 0 offen nt
    v_and_b32_dpp v44, v139, v8 row_newbcast:15 row_mask:0xf bank_mask:0xf
    v_and_b32_dpp v45, v139, v9 row_newbcast:15 row_mask:0xf bank_mask:0xf
    v_and_b32_dpp v46, v139, v10 row_newbcast:15 row_mask:0xf bank_mask:0xf
    v_and_b32_dpp v47, v139, v11 row_newbcast:15 row_mask:0xf bank_mask:0xf
    v_mov_b32_dpp v139, v139 row_shr:1 row_mask:0xf bank_mask:0xf
    s_nop 0
    v_mfma_f32_16x16x32_bf16 v[32:35], v[44:47], v[108:111], v[32:35]
    v_xor_b32 v156, s61, v156
    s_waitcnt vmcnt(6)
    buffer_load_dwordx4 v[80:83], v156, s[48:51], 0 offen nt
    v_and_b32_dpp v40, v140, v8 row_newbcast:15 row_mask:0xf bank_mask:0xf
    v_and_b32_dpp v41, v140, v9 row_newbcast:15 row_mask:0xf bank_mask:0xf
    v_and_b32_dpp v42, v140, v10 row_newbcast:15 row_mask:0xf bank_mask:0xf
    v_and_b32_dpp v43, v140, v11 row_newbcast:15 row_mask:0xf bank_mask:0xf
    v_mov_b32_dpp v140, v140 row_shr:1 row_mask:0xf bank_mask:0xf
    s_nop 0
    v_mfma_f32_16x16x32_bf16 v[32:35], v[40:43], v[112:115], v[32:35]
    v_xor_b32 v157, s61, v157
    s_waitcnt vmcnt(6)
    buffer_load_dwordx4 v[84:87], v157, s[48:51], 0 offen nt
    v_and_b32_dpp v44, v141, v8 row_newbcast:15 row_mask:0xf bank_mask:0xf
    v_and_b32_dpp v45, v141, v9 row_newbcast:15 row_mask:0xf bank_mask:0xf
    v_and_b32_dpp v46, v141, v10 row_newbcast:15 row_mask:0xf bank_mask:0xf
    v_and_b32_dpp v47, v141, v11 row_newbcast:15 row_mask:0xf bank_mask:0xf
    v_mov_b32_dpp v141, v141 row_shr:1 row_mask:0xf bank_mask:0xf
    s_nop 0
    v_mfma_f32_16x16x32_bf16 v[32:35], v[44:47], v[116:119], v[32:35]
    v_xor_b32 v158, s61, v158
    s_waitcnt vmcnt(6)
    buffer_load_dwordx4 v[88:91], v158, s[48:51], 0 offen nt
    v_and_b32_dpp v40, v142, v8 row_newbcast:15 row_mask:0xf bank_mask:0xf
    v_and_b32_dpp v41, v142, v9 row_newbcast:15 row_mask:0xf bank_mask:0xf
    v_and_b32_dpp v42, v142, v10 row_newbcast:15 row_mask:0xf bank_mask:0xf
    v_and_b32_dpp v43, v142, v11 row_newbcast:15 row_mask:0xf bank_mask:0xf
    v_mov_b32_dpp v142, v142 row_shr:1 row_mask:0xf bank_mask:0xf
    s_nop 0
    v_mfma_f32_16x16x32_bf16 v[32:35], v[40:43], v[120:123], v[32:35]
    v_xor_b32 v159, s61, v159
    s_waitcnt vmcnt(6)
    buffer_load_dwordx4 v[92:95], v159, s[48:51], 0 offen nt
    v_and_b32_dpp v44, v143, v8 row_newbcast:15 row_mask:0xf bank_mask:0xf
    v_and_b32_dpp v45, v143, v9 row_newbcast:15 row_mask:0xf bank_mask:0xf
    v_and_b32_dpp v46, v143, v10 row_newbcast:15 row_mask:0xf bank_mask:0xf
    v_and_b32_dpp v47, v143, v11 row_newbcast:15 row_mask:0xf bank_mask:0xf
    v_mov_b32_dpp v143, v143 row_shr:1 row_mask:0xf bank_mask:0xf
    s_nop 0
    v_mfma_f32_16x16x32_bf16 v[32:35], v[44:47], v[124:127], v[32:35]
    s_bitcmp1_b32 s63, s14
    s_cbranch_scc0 L_bvc3
    s_barrier
L_bvc3:
    s_add_u32 s64, s64, 1
    v_readlane_b32 s61, v160, s64
    s_nop 1
    v_xor_b32 v152, s61, v152
    s_waitcnt vmcnt(6)
    buffer_load_dwordx4 v[96:99], v152, s[48:51], 0 offen nt
    v_and_b32_dpp v40, v128, v8 row_newbcast:15 row_mask:0xf bank_mask:0xf
    v_and_b32_dpp v41, v128, v9 row_newbcast:15 row_mask:0xf bank_mask:0xf
    v_and_b32_dpp v42, v128, v10 row_newbcast:15 row_mask:0xf bank_mask:0xf
    v_and_b32_dpp v43, v128, v11 row_newbcast:15 row_mask:0xf bank_mask:0xf
    v_mov_b32_dpp v128, v128 row_shr:1 row_mask:0xf bank_mask:0xf
    s_nop 0
    v_mfma_f32_16x16x32_bf16 v[32:35], v[40:43], v[64:67], v[32:35]
    v_xor_b32 v153, s61, v153
    s_waitcnt vmcnt(6)
    buffer_load_dwordx4 v[100:103], v153, s[48:51], 0 offen nt
    v_and_b32_dpp v44, v129, v8 row_newbcast:15 row_mask:0xf bank_mask:0xf
    v_and_b32_dpp v45, v129, v9 row_newbcast:15 row_mask:0xf bank_mask:0xf
    v_and_b32_dpp v46, v129, v10 row_newbcast:15 row_mask:0xf bank_mask:0xf
    v_and_b32_dpp v47, v129, v11 row_newbcast:15 row_mask:0xf bank_mask:0xf
    v_mov_b32_dpp v129, v129 row_shr:1 row_mask:0xf bank_mask:0xf
    s_nop 0
    v_mfma_f32_16x16x32_bf16 v[32:35], v[44:47], v[68:71], v[32:35]
    v_xor_b32 v154, s61, v154
    s_waitcnt vmcnt(6)
    buffer_load_dwordx4 v[104:107], v154, s[48:51], 0 offen nt
    v_and_b32_dpp v40, v130, v8 row_newbcast:15 row_mask:0xf bank_mask:0xf
    v_and_b32_dpp v41, v130, v9 row_newbcast:15 row_mask:0xf bank_mask:0xf
    v_and_b32_dpp v42, v130, v10 row_newbcast:15 row_mask:0xf bank_mask:0xf
    v_and_b32_dpp v43, v130, v11 row_newbcast:15 row_mask:0xf bank_mask:0xf
    v_mov_b32_dpp v130, v130 row_shr:1 row_mask:0xf bank_mask:0xf
    s_nop 0
    v_mfma_f32_16x16x32_bf16 v[32:35], v[40:43], v[72:75], v[32:35]
    v_xor_b32 v155, s61, v155
    s_waitcnt vmcnt(6)
    buffer_load_dwordx4 v[108:111], v155, s[48:51], 0 offen nt
    v_and_b32_dpp v44, v131, v8 row_newbcast:15 row_mask:0xf bank_mask:0xf
    v_and_b32_dpp v45, v131, v9 row_newbcast:15 row_mask:0xf bank_mask:0xf
    v_and_b32_dpp v46, v131, v10 row_newbcast:15 row_mask:0xf bank_mask:0xf
    v_and_b32_dpp v47, v131, v11 row_newbcast:15 row_mask:0xf bank_mask:0xf
    v_mov_b32_dpp v131, v131 row_shr:1 row_mask:0xf bank_mask:0xf
    s_nop 0
    v_mfma_f32_16x16x32_bf16 v[32:35], v[44:47], v[76:79], v[32:35]
    v_xor_b32 v156, s61, v156
    s_waitcnt vmcnt(6)
    buffer_load_dwordx4 v[112:115], v156, s[48:51], 0 offen nt
    v_and_b32_dpp v40, v132, v8 row_newbcast:15 row_mask:0xf bank_mask:0xf
    v_and_b32_dpp v41, v132, v9 row_newbcast:15 row_mask:0xf bank_mask:0xf
    v_and_b32_dpp v42, v132, v10 row_newbcast:15 row_mask:0xf bank_mask:0xf
    v_and_b32_dpp v43, v132, v11 row_newbcast:15 row_mask:0xf bank_mask:0xf
    v_mov_b32_dpp v132, v132 row_shr:1 row_mask:0xf bank_mask:0xf
    s_nop 0
    v_mfma_f32_16x16x32_bf16 v[32:35], v[40:43], v[80:83], v[32:35]
    v_xor_b32 v157, s61, v157
    s_waitcnt vmcnt(6)
    buffer_load_dwordx4 v[116:119], v157, s[48:51], 0 offen nt
    v_and_b32_dpp v44, v133, v8 row_newbcast:15 row_mask:0xf bank_mask:0xf
    v_and_b32_dpp v45, v133, v9 row_newbcast:15 row_mask:0xf bank_mask:0xf
    v_and_b32_dpp v46, v133, v10 row_newbcast:15 row_mask:0xf bank_mask:0xf
    v_and_b32_dpp v47, v133, v11 row_newbcast:15 row_mask:0xf bank_mask:0xf
    v_mov_b32_dpp v133, v133 row_shr:1 row_mask:0xf bank_mask:0xf
    s_nop 0
    v_mfma_f32_16x16x32_bf16 v[32:35], v[44:47], v[84:87], v[32:35]
    v_xor_b32 v158, s61, v158
    s_waitcnt vmcnt(6)
    buffer_load_dwordx4 v[120:123], v158, s[48:51], 0 offen nt
    v_and_b32_dpp v40, v134, v8 row_newbcast:15 row_mask:0xf bank_mask:0xf
    v_and_b32_dpp v41, v134, v9 row_newbcast:15 row_mask:0xf bank_mask:0xf
    v_and_b32_dpp v42, v134, v10 row_newbcast:15 row_mask:0xf bank_mask:0xf
    v_and_b32_dpp v43, v134, v11 row_newbcast:15 row_mask:0xf bank_mask:0xf
    v_mov_b32_dpp v134, v134 row_shr:1 row_mask:0xf bank_mask:0xf
    s_nop 0
    v_mfma_f32_16x16x32_bf16 v[32:35], v[40:43], v[88:91], v[32:35]
    v_xor_b32 v159, s61, v159
    s_waitcnt vmcnt(6)
    buffer_load_dwordx4 v[124:127], v159, s[48:51], 0 offen nt
    v_and_b32_dpp v44, v135, v8 row_newbcast:15 row_mask:0xf bank_mask:0xf
    v_and_b32_dpp v45, v135, v9 row_newbcast:15 row_mask:0xf bank_mask:0xf
    v_and_b32_dpp v46, v135, v10 row_newbcast:15 row_mask:0xf bank_mask:0xf
    v_and_b32_dpp v47, v135, v11 row_newbcast:15 row_mask:0xf bank_mask:0xf
    v_mov_b32_dpp v135, v135 row_shr:1 row_mask:0xf bank_mask:0xf
    s_nop 0
    v_mfma_f32_16x16x32_bf16 v[32:35], v[44:47], v[92:95], v[32:35]
    ds_read_b32 v60, v61 offset:1536
    s_sub_u32 s14, s14, 1
    s_cmp_eq_u32 s14, 0
    s_cbranch_scc1 L_bvend
    s_waitcnt lgkmcnt(0)
    v_readfirstlane_b32 s10, v60
    s_cmp_eq_u32 s10, 0
    s_cbranch_scc1 L_bv0
    s_cmp_eq_u32 s10, 1
    s_cbranch_scc1 L_bv1
    s_cmp_eq_u32 s10, 2
    s_cbranch_scc1 L_bv2
    s_branch L_bv3
.p2align 12
L_bvend:
    ds_read_b128 v[72:75], v56 offset:4096
    v_and_b32_dpp v40, v136, v8 row_newbcast:15 row_mask:0xf bank_mask:0xf
    v_and_b32_dpp v41, v136, v9 row_newbcast:15 row_mask:0xf bank_mask:0xf
    v_and_b32_dpp v42, v136, v10 row_newbcast:15 row_mask:0xf bank_mask:0xf
    v_and_b32_dpp v43, v136, v11 row_newbcast:15 row_mask:0xf bank_mask:0xf
    s_waitcnt vmcnt(7)
    s_nop 0
    v_mfma_f32_16x16x32_bf16 v[32:35], v[40:43], v[96:99], v[32:35]
    v_and_b32_dpp v44, v137, v8 row_newbcast:15 row_mask:0xf bank_mask:0xf
    v_and_b32_dpp v45, v137, v9 row_newbcast:15 row_mask:0xf bank_mask:0xf
    v_and_b32_dpp v46, v137, v10 row_newbcast:15 row_mask:0xf bank_mask:0xf
    v_and_b32_dpp v47, v137, v11 row_newbcast:15 row_mask:0xf bank_mask:0xf
    s_waitcnt vmcnt(6)
    s_nop 0
    v_mfma_f32_16x16x32_bf16 v[32:35], v[44:47], v[100:103], v[32:35]
    s_barrier
    v_and_b32_dpp v40, v138, v8 row_newbcast:15 row_mask:0xf bank_mask:0xf
    v_and_b32_dpp v41, v138, v9 row_newbcast:15 row_mask:0xf bank_mask:0xf
    v_and_b32_dpp v42, v138, v10 row_newbcast:15 row_mask:0xf bank_mask:0xf
    v_and_b32_dpp v43, v138, v11 row_newbcast:15 row_mask:0xf bank_mask:0xf
    s_waitcnt vmcnt(5)
    s_nop 0
    v_mfma_f32_16x16x32_bf16 v[32:35], v[40:43], v[104:107], v[32:35]
    v_and_b32_dpp v44, v139, v8 row_newbcast:15 row_mask:0xf bank_mask:0xf
    v_and_b32_dpp v45, v139, v9 row_newbcast:15 row_mask:0xf bank_mask:0xf
    v_and_b32_dpp v46, v139, v10 row_newbcast:15 row_mask:0xf bank_mask:0xf
    v_and_b32_dpp v47, v139, v11 row_newbcast:15 row_mask:0xf bank_mask:0xf
    s_waitcnt vmcnt(4)
    s_nop 0
    v_mfma_f32_16x16x32_bf16 v[32:35], v[44:47], v[108:111], v[32:35]
    v_and_b32_dpp v40, v140, v8 row_newbcast:15 row_mask:0xf bank_mask:0xf
    v_and_b32_dpp v41, v140, v9 row_newbcast:15 row_mask:0xf bank_mask:0xf
    v_and_b32_dpp v42, v140, v10 row_newbcast:15 row_mask:0xf bank_mask:0xf
    v_and_b32_dpp v43, v140, v11 row_newbcast:15 row_mask:0xf bank_mask:0xf
    s_waitcnt vmcnt(3)
    s_nop 0
    v_mfma_f32_16x16x32_bf16 v[32:35], v[40:43], v[112:115], v[32:35]
    v_and_b32_dpp v44, v141, v8 row_newbcast:15 row_mask:0xf bank_mask:0xf
    v_and_b32_dpp v45, v141, v9 row_newbcast:15 row_mask:0xf bank_mask:0xf
    v_and_b32_dpp v46, v141, v10 row_newbcast:15 row_mask:0xf bank_mask:0xf
    v_and_b32_dpp v47, v141, v11 row_newbcast:15 row_mask:0xf bank_mask:0xf
    s_waitcnt vmcnt(2)
    s_nop 0
    v_mfma_f32_16x16x32_bf16 v[32:35], v[44:47], v[116:119], v[32:35]
    v_and_b32_dpp v40, v142, v8 row_newbcast:15 row_mask:0xf bank_mask:0xf
    v_and_b32_dpp v41, v142, v9 row_newbcast:15 row_mask:0xf bank_mask:0xf
    v_and_b32_dpp v42, v142, v10 row_newbcast:15 row_mask:0xf bank_mask:0xf
    v_and_b32_dpp v43, v142, v11 row_newbcast:15 row_mask:0xf bank_mask:0xf
    s_waitcnt vmcnt(1)
    s_nop 0
    v_mfma_f32_16x16x32_bf16 v[32:35], v[40:43], v[120:123], v[32:35]
    s_barrier
    v_and_b32_dpp v44, v143, v8 row_newbcast:15 row_mask:0xf bank_mask:0xf
    v_and_b32_dpp v45, v143, v9 row_newbcast:15 row_mask:0xf bank_mask:0xf
    v_and_b32_dpp v46, v143, v10 row_newbcast:15 row_mask:0xf bank_mask:0xf
    v_and_b32_dpp v47, v143, v11 row_newbcast:15 row_mask:0xf bank_mask:0xf
    s_waitcnt vmcnt(0)
    s_nop 0
    v_mfma_f32_16x16x32_bf16 v[32:35], v[44:47], v[124:127], v[32:35]
    s_mov_b32 exec_hi, 0
    s_nop 6
    ds_write_b128 v57, v[32:35] offset:2048
    s_mov_b32 exec_lo, 1
    ds_add_rtn_u32 v5, v61, v62 offset:1540
    s_mov_b64 exec, -1
    ds_read_b128 v[64:67], v56 offset:2048
    ds_read_b128 v[68:71], v56 offset:3072
    s_waitcnt lgkmcnt(0)
    v_readfirstlane_b32 s10, v5
    s_cmp_eq_u32 s10, 3
    s_cbranch_scc0 L_end
    s_call_b64 s[90:91], F_out
    s_mov_b32 exec_hi, 0
    global_store_dwordx2 v74, v[64:65], s[40:41] sc1
    s_endpgm
L_hb1:
    s_add_u32 s69, s6, s8
    s_add_u32 s69, s69, 2
    s_and_b32 s69, s69, 3
    s_and_b32 s10, s68, 0xfc
    s_or_b32 s69, s69, s10
    s_and_b32 s10, s69, 31
    s_lshl_b32 s10, s10, 3
    s_and_b32 s11, s2, 7
    s_or_b32 s10, s10, s11
    s_lshl_b32 s10, s10, 12
    s_add_u32 s10, s10, 1048576
    v_add_u32 v50, s10, v56
    s_lshl_b32 s11, s8, 8
    s_add_u32 s11, s11, 256
    v_add_u32 v51, s11, v55
    v_and_b32 v6, 3, v2
    v_lshl_add_u32 v6, v1, 2, v6
    v_lshl_add_u32 v49, v6, 4, s11
    v_and_b32 v5, 1, v2
    v_cmp_eq_u32 vcc, 1, v5
    v_mov_b32 v7, 0xffff
    v_mov_b32 v5, 0xffff0000
    v_cndmask_b32 v7, v7, v5, vcc
    v_bfe_u32 v5, v2, 1, 2
    v_cmp_eq_u32 vcc, 0, v5
    s_nop 1
    v_cndmask_b32 v8, 0, v7, vcc
    v_cmp_eq_u32 vcc, 1, v5
    s_nop 1
    v_cndmask_b32 v9, 0, v7, vcc
    v_cmp_eq_u32 vcc, 2, v5
    s_nop 1
    v_cndmask_b32 v10, 0, v7, vcc
    v_cmp_eq_u32 vcc, 3, v5
    s_nop 1
    v_cndmask_b32 v11, 0, v7, vcc
    v_mov_b32 v112, 0xff7fffff
    v_mov_b32 v113, 0xff7fffff
    v_mov_b32 v114, 0xff7fffff
    v_mov_b32 v115, 0xff7fffff
    v_mov_b32 v116, 0xff7fffff
    v_mov_b32 v117, 0xff7fffff
    v_mov_b32 v118, 0xff7fffff
    v_mov_b32 v119, 0xff7fffff
    v_mov_b32 v5, 0
    v_mov_b32 v6, 1
    v_mov_b32 v7, 0
    ds_write_b64 v5, v[6:7] offset:1536
    v_add_u32 v48, 8192, v56
    s_mov_b32 s14, 8
    s_waitcnt lgkmcnt(0)
    s_barrier
    s_setprio 0
    s_mov_b32 exec_hi, 0
    global_load_dword v53, v54, s[40:41] sc1
    s_mov_b64 exec, -1
    s_call_b64 s[90:91], F_getq
    v_cmp_ne_u32 vcc, s92, v53
    s_mov_b32 s92, vcc_lo
    s_waitcnt lgkmcnt(0)
    ds_read_b128 v[16:19], v49
L_ak:
    ds_read_b128 v[64:67], v48 offset:0
    ds_read_b128 v[68:71], v48 offset:1024
    ds_read_b128 v[72:75], v48 offset:2048
    ds_read_b128 v[76:79], v48 offset:3072
    ds_read_b128 v[80:83], v48 offset:4096
    ds_read_b128 v[84:87], v48 offset:5120
    ds_read_b128 v[88:91], v48 offset:6144
    ds_read_b128 v[92:95], v48 offset:7168
    v_add_u32 v48, 0x2000, v48
    s_sub_u32 s14, s14, 1
    s_waitcnt lgkmcnt(7)
    v_mfma_f32_16x16x32_bf16 v[24:27], v[64:67], v[16:19], 0
    s_waitcnt lgkmcnt(6)
    v_mfma_f32_16x16x32_bf16 v[28:31], v[68:71], v[16:19], 0
    s_waitcnt lgkmcnt(5)
    v_mfma_f32_16x16x32_bf16 v[32:35], v[72:75], v[16:19], 0
    s_nop 3
    v_add_f32_dpp v27, v26, v27 quad_perm:[2,2,2,2] row_mask:0xf bank_mask:0xf
    v_add_f32_dpp v24, v25, v24 quad_perm:[1,1,1,1] row_mask:0xf bank_mask:0xf
    v_mov_b32_dpp v112, v112 row_shr:1 row_mask:0xf bank_mask:0xf
    s_waitcnt lgkmcnt(4)
    v_mfma_f32_16x16x32_bf16 v[36:39], v[76:79], v[16:19], 0
    v_add_f32_dpp v112, v27, v24 row_shl:15 row_mask:0xf bank_mask:0xf
    v_add_f32_dpp v31, v30, v31 quad_perm:[2,2,2,2] row_mask:0xf bank_mask:0xf
    v_add_f32_dpp v28, v29, v28 quad_perm:[1,1,1,1] row_mask:0xf bank_mask:0xf
    v_mov_b32_dpp v113, v113 row_shr:1 row_mask:0xf bank_mask:0xf
    s_waitcnt lgkmcnt(3)
    v_mfma_f32_16x16x32_bf16 v[24:27], v[80:83], v[16:19], 0
    v_add_f32_dpp v113, v31, v28 row_shl:15 row_mask:0xf bank_mask:0xf
    v_add_f32_dpp v35, v34, v35 quad_perm:[2,2,2,2] row_mask:0xf bank_mask:0xf
    v_add_f32_dpp v32, v33, v32 quad_perm:[1,1,1,1] row_mask:0xf bank_mask:0xf
    v_mov_b32_dpp v114, v114 row_shr:1 row_mask:0xf bank_mask:0xf
    s_waitcnt lgkmcnt(2)
    v_mfma_f32_16x16x32_bf16 v[28:31], v[84:87], v[16:19], 0
    v_add_f32_dpp v114, v35, v32 row_shl:15 row_mask:0xf bank_mask:0xf
    v_add_f32_dpp v39, v38, v39 quad_perm:[2,2,2,2] row_mask:0xf bank_mask:0xf
    v_add_f32_dpp v36, v37, v36 quad_perm:[1,1,1,1] row_mask:0xf bank_mask:0xf
    v_mov_b32_dpp v115, v115 row_shr:1 row_mask:0xf bank_mask:0xf
    s_waitcnt lgkmcnt(1)
    v_mfma_f32_16x16x32_bf16 v[32:35], v[88:91], v[16:19], 0
    v_add_f32_dpp v115, v39, v36 row_shl:15 row_mask:0xf bank_mask:0xf
    v_add_f32_dpp v27, v26, v27 quad_perm:[2,2,2,2] row_mask:0xf bank_mask:0xf
    v_add_f32_dpp v24, v25, v24 quad_perm:[1,1,1,1] row_mask:0xf bank_mask:0xf
    v_mov_b32_dpp v116, v116 row_shr:1 row_mask:0xf bank_mask:0xf
    s_waitcnt lgkmcnt(0)
    v_mfma_f32_16x16x32_bf16 v[36:39], v[92:95], v[16:19], 0
    v_add_f32_dpp v116, v27, v24 row_shl:15 row_mask:0xf bank_mask:0xf
    v_add_f32_dpp v31, v30, v31 quad_perm:[2,2,2,2] row_mask:0xf bank_mask:0xf
    v_add_f32_dpp v28, v29, v28 quad_perm:[1,1,1,1] row_mask:0xf bank_mask:0xf
    v_mov_b32_dpp v117, v117 row_shr:1 row_mask:0xf bank_mask:0xf
    s_nop 1
    v_add_f32_dpp v117, v31, v28 row_shl:15 row_mask:0xf bank_mask:0xf
    v_add_f32_dpp v35, v34, v35 quad_perm:[2,2,2,2] row_mask:0xf bank_mask:0xf
    v_add_f32_dpp v32, v33, v32 quad_perm:[1,1,1,1] row_mask:0xf bank_mask:0xf
    v_mov_b32_dpp v118, v118 row_shr:1 row_mask:0xf bank_mask:0xf
    s_nop 1
    v_add_f32_dpp v118, v35, v32 row_shl:15 row_mask:0xf bank_mask:0xf
    v_add_f32_dpp v39, v38, v39 quad_perm:[2,2,2,2] row_mask:0xf bank_mask:0xf
    v_add_f32_dpp v36, v37, v36 quad_perm:[1,1,1,1] row_mask:0xf bank_mask:0xf
    v_mov_b32_dpp v119, v119 row_shr:1 row_mask:0xf bank_mask:0xf
    s_nop 1
    v_add_f32_dpp v119, v39, v36 row_shl:15 row_mask:0xf bank_mask:0xf
    s_cmp_eq_u32 s14, 0
    s_cbranch_scc0 L_ak
    v_max3_f32 v36, v112, v113, v114
    v_max3_f32 v36, v36, v115, v116
    v_max3_f32 v36, v36, v117, v118
    v_max_f32 v36, v36, v119
    s_nop 1
    v_max_f32_dpp v36, v36, v36 row_ror:8 row_mask:0xf bank_mask:0xf
    s_nop 1
    v_max_f32_dpp v36, v36, v36 row_ror:4 row_mask:0xf bank_mask:0xf
    s_nop 1
    v_max_f32_dpp v36, v36, v36 row_ror:2 row_mask:0xf bank_mask:0xf
    s_nop 1
    v_max_f32_dpp v36, v36, v36 row_ror:1 row_mask:0xf bank_mask:0xf
    v_mov_b32 v5, v36
    s_nop 1
    v_permlane32_swap_b32 v5, v36
    v_max_f32 v36, v36, v5
    v_mov_b32 v5, v36
    s_nop 1
    v_permlane16_swap_b32 v5, v36
    v_max_f32 v36, v36, v5
    v_mul_f32 v38, s9, v36
    v_fma_f32 v112, v112, s9, -v38
    v_fma_f32 v113, v113, s9, -v38
    v_fma_f32 v114, v114, s9, -v38
    v_fma_f32 v115, v115, s9, -v38
    v_fma_f32 v116, v116, s9, -v38
    v_fma_f32 v117, v117, s9, -v38
    v_fma_f32 v118, v118, s9, -v38
    v_fma_f32 v119, v119, s9, -v38
    v_exp_f32 v112, v112
    v_exp_f32 v113, v113
    v_exp_f32 v114, v114
    v_exp_f32 v115, v115
    v_exp_f32 v116, v116
    v_exp_f32 v117, v117
    v_exp_f32 v118, v118
    v_exp_f32 v119, v119
    v_add_f32 v37, v112, v113
    v_add_f32 v37, v37, v114
    v_add_f32 v37, v37, v115
    v_add_f32 v37, v37, v116
    v_add_f32 v37, v37, v117
    v_add_f32 v37, v37, v118
    v_add_f32 v37, v37, v119
    v_cvt_pk_bf16_f32 v112, v112, v112
    v_cvt_pk_bf16_f32 v113, v113, v113
    v_cvt_pk_bf16_f32 v114, v114, v114
    v_cvt_pk_bf16_f32 v115, v115, v115
    v_cvt_pk_bf16_f32 v116, v116, v116
    v_cvt_pk_bf16_f32 v117, v117, v117
    v_cvt_pk_bf16_f32 v118, v118, v118
    v_cvt_pk_bf16_f32 v119, v119, v119
    v_add_f32_dpp v37, v37, v37 row_ror:8 row_mask:0xf bank_mask:0xf
    s_nop 1
    v_add_f32_dpp v37, v37, v37 row_ror:4 row_mask:0xf bank_mask:0xf
    s_nop 1
    v_add_f32_dpp v37, v37, v37 row_ror:2 row_mask:0xf bank_mask:0xf
    s_nop 1
    v_add_f32_dpp v37, v37, v37 row_ror:1 row_mask:0xf bank_mask:0xf
    v_mov_b32 v5, v37
    s_nop 1
    v_permlane32_swap_b32 v5, v37
    v_add_f32 v37, v37, v5
    v_mov_b32 v5, v37
    s_nop 1
    v_permlane16_swap_b32 v5, v37
    v_add_f32 v37, v37, v5
    v_mov_b32 v32, 0
    v_mov_b32 v33, 0
    v_mov_b32 v34, 0
    v_mov_b32 v35, 0
    s_mov_b32 s14, 8
L_av:
    ds_read_b128 v[64:67], v48 offset:0
    ds_read_b128 v[68:71], v48 offset:1024
    ds_read_b128 v[72:75], v48 offset:2048
    ds_read_b128 v[76:79], v48 offset:3072
    ds_read_b128 v[80:83], v48 offset:4096
    ds_read_b128 v[84:87], v48 offset:5120
    ds_read_b128 v[88:91], v48 offset:6144
    ds_read_b128 v[92:95], v48 offset:7168
    v_add_u32 v48, 0x2000, v48
    s_sub_u32 s14, s14, 1
    v_and_b32_dpp v40, v112, v8 row_newbcast:7 row_mask:0xf bank_mask:0xf
    v_and_b32_dpp v41, v112, v9 row_newbcast:7 row_mask:0xf bank_mask:0xf
    v_and_b32_dpp v42, v112, v10 row_newbcast:7 row_mask:0xf bank_mask:0xf
    v_and_b32_dpp v43, v112, v11 row_newbcast:7 row_mask:0xf bank_mask:0xf
    v_mov_b32_dpp v112, v112 row_shr:1 row_mask:0xf bank_mask:0xf
    s_waitcnt lgkmcnt(7)
    v_mfma_f32_16x16x32_bf16 v[32:35], v[40:43], v[64:67], v[32:35]
    v_and_b32_dpp v44, v113, v8 row_newbcast:7 row_mask:0xf bank_mask:0xf
    v_and_b32_dpp v45, v113, v9 row_newbcast:7 row_mask:0xf bank_mask:0xf
    v_and_b32_dpp v46, v113, v10 row_newbcast:7 row_mask:0xf bank_mask:0xf
    v_and_b32_dpp v47, v113, v11 row_newbcast:7 row_mask:0xf bank_mask:0xf
    v_mov_b32_dpp v113, v113 row_shr:1 row_mask:0xf bank_mask:0xf
    s_waitcnt lgkmcnt(6)
    v_mfma_f32_16x16x32_bf16 v[32:35], v[44:47], v[68:71], v[32:35]
    v_and_b32_dpp v40, v114, v8 row_newbcast:7 row_mask:0xf bank_mask:0xf
    v_and_b32_dpp v41, v114, v9 row_newbcast:7 row_mask:0xf bank_mask:0xf
    v_and_b32_dpp v42, v114, v10 row_newbcast:7 row_mask:0xf bank_mask:0xf
    v_and_b32_dpp v43, v114, v11 row_newbcast:7 row_mask:0xf bank_mask:0xf
    v_mov_b32_dpp v114, v114 row_shr:1 row_mask:0xf bank_mask:0xf
    s_waitcnt lgkmcnt(5)
    v_mfma_f32_16x16x32_bf16 v[32:35], v[40:43], v[72:75], v[32:35]
    v_and_b32_dpp v44, v115, v8 row_newbcast:7 row_mask:0xf bank_mask:0xf
    v_and_b32_dpp v45, v115, v9 row_newbcast:7 row_mask:0xf bank_mask:0xf
    v_and_b32_dpp v46, v115, v10 row_newbcast:7 row_mask:0xf bank_mask:0xf
    v_and_b32_dpp v47, v115, v11 row_newbcast:7 row_mask:0xf bank_mask:0xf
    v_mov_b32_dpp v115, v115 row_shr:1 row_mask:0xf bank_mask:0xf
    s_waitcnt lgkmcnt(4)
    v_mfma_f32_16x16x32_bf16 v[32:35], v[44:47], v[76:79], v[32:35]
    v_and_b32_dpp v40, v116, v8 row_newbcast:7 row_mask:0xf bank_mask:0xf
    v_and_b32_dpp v41, v116, v9 row_newbcast:7 row_mask:0xf bank_mask:0xf
    v_and_b32_dpp v42, v116, v10 row_newbcast:7 row_mask:0xf bank_mask:0xf
    v_and_b32_dpp v43, v116, v11 row_newbcast:7 row_mask:0xf bank_mask:0xf
    v_mov_b32_dpp v116, v116 row_shr:1 row_mask:0xf bank_mask:0xf
    s_waitcnt lgkmcnt(3)
    v_mfma_f32_16x16x32_bf16 v[32:35], v[40:43], v[80:83], v[32:35]
    v_and_b32_dpp v44, v117, v8 row_newbcast:7 row_mask:0xf bank_mask:0xf
    v_and_b32_dpp v45, v117, v9 row_newbcast:7 row_mask:0xf bank_mask:0xf
    v_and_b32_dpp v46, v117, v10 row_newbcast:7 row_mask:0xf bank_mask:0xf
    v_and_b32_dpp v47, v117, v11 row_newbcast:7 row_mask:0xf bank_mask:0xf
    v_mov_b32_dpp v117, v117 row_shr:1 row_mask:0xf bank_mask:0xf
    s_waitcnt lgkmcnt(2)
    v_mfma_f32_16x16x32_bf16 v[32:35], v[44:47], v[84:87], v[32:35]
    v_and_b32_dpp v40, v118, v8 row_newbcast:7 row_mask:0xf bank_mask:0xf
    v_and_b32_dpp v41, v118, v9 row_newbcast:7 row_mask:0xf bank_mask:0xf
    v_and_b32_dpp v42, v118, v10 row_newbcast:7 row_mask:0xf bank_mask:0xf
    v_and_b32_dpp v43, v118, v11 row_newbcast:7 row_mask:0xf bank_mask:0xf
    v_mov_b32_dpp v118, v118 row_shr:1 row_mask:0xf bank_mask:0xf
    s_waitcnt lgkmcnt(1)
    v_mfma_f32_16x16x32_bf16 v[32:35], v[40:43], v[88:91], v[32:35]
    v_and_b32_dpp v44, v119, v8 row_newbcast:7 row_mask:0xf bank_mask:0xf
    v_and_b32_dpp v45, v119, v9 row_newbcast:7 row_mask:0xf bank_mask:0xf
    v_and_b32_dpp v46, v119, v10 row_newbcast:7 row_mask:0xf bank_mask:0xf
    v_and_b32_dpp v47, v119, v11 row_newbcast:7 row_mask:0xf bank_mask:0xf
    v_mov_b32_dpp v119, v119 row_shr:1 row_mask:0xf bank_mask:0xf
    s_waitcnt lgkmcnt(0)
    v_mfma_f32_16x16x32_bf16 v[32:35], v[44:47], v[92:95], v[32:35]
    s_cmp_eq_u32 s14, 0
    s_cbranch_scc0 L_av
    s_xor_b32 s66, s70, 256
    v_mov_b32 v7, s66
    s_cmp_eq_u32 s8, 2
    s_cbranch_scc1 L_h23
    s_lshl_b32 s11, s8, 9
    s_add_u32 s11, s11, 2048
    v_add_u32 v5, s11, v50
    s_lshl_b32 s11, s8, 4
    s_add_u32 s11, s11, 2560
    v_bfi_b32 v64, s72, v7, v32
    v_bfi_b32 v65, s72, v7, v33
    v_bfi_b32 v66, s72, v7, v34
    v_bfi_b32 v67, s72, v7, v35
    s_mov_b32 exec_lo, 0
    v_add_u32 v5, s11, v50
    v_bfi_b32 v64, s72, v7, v36
    v_lshl_or_b32 v65, v36, 22, v7
    v_bfi_b32 v66, s72, v7, v37
    v_lshl_or_b32 v67, v37, 22, v7
    s_mov_b32 exec_lo, -1
    s_mov_b32 exec_hi, 1
    s_cmp_eq_u32 s92, 0
    s_cbranch_scc0 L_ap0
    global_store_dwordx4 v5, v[64:67], s[40:41]
    s_branch L_ap1
L_ap0:
    global_store_dwordx4 v5, v[64:67], s[40:41] sc1
L_ap1:
    s_mov_b64 exec, -1
    s_cmp_eq_u32 s8, 3
    s_cbranch_scc1 L_h23
    s_endpgm
L_h23:
    v_add_u32 v52, 0x80, v54
    s_lshl_b32 s12, s42, 16
    s_add_u32 s12, s12, 3145728
    s_lshl_b32 s11, s64, 11
    s_add_u32 s10, s12, s11
    v_and_b32 v5, 7, v2
    v_lshl_add_u32 v5, v5, 8, s10
    v_lshrrev_b32 v6, 3, v2
    v_lshl_add_u32 v5, v6, 6, v5
    v_lshl_add_u32 v53, v1, 4, v5
    s_lshl_b32 s11, s6, 11
    s_add_u32 s10, s12, s11
    s_lshl_b32 s11, s7, 8
    s_add_u32 s10, s10, s11
    v_lshl_add_u32 v5, v6, 6, s10
    v_bfe_u32 v6, v2, 2, 1
    v_lshl_add_u32 v5, v6, 7, v5
    v_lshl_add_u32 v5, v1, 3, v5
    v_and_b32 v6, 3, v2
    v_lshl_add_u32 v54, v6, 4, v5
    s_lshl_b32 s10, s65, 12
    s_lshl_b32 s11, s64, 7
    s_add_u32 s10, s10, s11
    s_lshl_b32 s11, s42, 6
    s_add_u32 s10, s10, s11
    s_add_u32 s10, s10, 1048576
    v_lshrrev_b32 v5, 2, v2
    v_lshl_add_u32 v5, v5, 15, s10
    v_and_b32 v6, 3, v2
    v_lshl_add_u32 v5, v6, 4, v5
    v_and_b32 v6, 1, v1
    v_lshl_add_u32 v58, v6, 19, v5
    v_add_u32 v59, 0x20000, v58
    v_add_u32 v60, 0x40000, v58
    v_add_u32 v61, 0x60000, v58
    s_cmp_eq_u32 s8, 3
    s_cbranch_scc1 L_h3
    v_add_u32 v5, 2048, v50
    s_lshl_b32 s11, s2, 12
    s_add_u32 s11, s11, 1051648
    v_lshl_add_u32 v7, v57, 4, s11
    s_barrier
    s_barrier
    s_mov_b32 exec_hi, 0
    s_mov_b32 exec_lo, 0xfffffff4
    v_mov_b32 v84, v62
    v_mov_b32 v85, v62
    v_mov_b32 v86, v62
    v_mov_b32 v87, v62
    s_cmp_eq_u32 s92, 0
    s_cbranch_scc0 L_fs0
    global_store_dwordx4 v5, v[84:87], s[40:41] offset:1024
    s_branch L_fs1
L_fs0:
    global_store_dwordx4 v5, v[84:87], s[40:41] offset:1024 sc1
L_fs1:
    s_mov_b32 exec_hi, 0
    global_load_dwordx4 v[88:91], v5, s[40:41] offset:1024 sc1 nt
    s_mov_b64 exec, -1
    s_mov_b32 s63, 0x4000
L_pa:
    global_load_dwordx4 v[64:67], v5, s[40:41] sc1 nt
    global_load_dwordx4 v[72:75], v7, s[40:41] sc1 nt
    s_waitcnt vmcnt(0)
    v_xor_b32 v64, s66, v64
    v_xor_b32 v65, s66, v65
    v_xor_b32 v66, s66, v66
    v_xor_b32 v67, s66, v67
    v_or_b32 v6, v64, v65
    v_or3_b32 v6, v6, v66, v67
    v_xor_b32 v72, s66, v72
    v_xor_b32 v73, s66, v73
    v_xor_b32 v74, s66, v74
    v_xor_b32 v75, s66, v75
    v_or_b32 v16, v72, v73
    v_or3_b32 v16, v16, v74, v75
    v_or_b32 v6, v6, v16
    v_and_b32 v6, s72, v6
    v_cmp_ne_u32 vcc, 0, v6
    s_and_b64 exec, exec, vcc
    s_cbranch_execz L_pa_ok
    s_sub_u32 s63, s63, 1
    s_cbranch_scc1 L_pa_ok
    s_sleep 16
    s_branch L_pa
L_pa_ok:
    s_mov_b64 exec, -1
    s_mov_b32 exec_lo, 0
    s_mov_b32 s63, 0x4000
L_pb:
    global_load_dwordx4 v[68:71], v5, s[40:41] offset:1024 sc1 nt
    global_load_dwordx4 v[76:79], v7, s[40:41] offset:32 sc1 nt
    s_waitcnt vmcnt(0)
    v_xor_b32 v68, s66, v68
    v_xor_b32 v69, s66, v69
    v_xor_b32 v70, s66, v70
    v_xor_b32 v71, s66, v71
    v_or_b32 v6, v68, v69
    v_or3_b32 v6, v6, v70, v71
    v_xor_b32 v76, s66, v76
    v_xor_b32 v77, s66, v77
    v_xor_b32 v78, s66, v78
    v_xor_b32 v79, s66, v79
    v_or_b32 v16, v76, v77
    v_or3_b32 v16, v16, v78, v79
    v_or_b32 v6, v6, v16
    v_and_b32 v6, s72, v6
    v_cmp_ne_u32 vcc, 0, v6
    s_and_b64 exec, exec, vcc
    s_cbranch_execz L_pb_ok
    s_sub_u32 s63, s63, 1
    s_cbranch_scc1 L_pb_ok
    s_sleep 16
    s_branch L_pb
L_pb_ok:
    s_mov_b64 exec, -1
    v_lshrrev_b32 v73, 22, v73
    v_lshrrev_b32 v75, 22, v75
    v_lshrrev_b32 v77, 22, v77
    v_lshrrev_b32 v79, 22, v79
    v_or_b32 v72, v72, v73
    v_or_b32 v73, v74, v75
    v_or_b32 v76, v76, v77
    v_or_b32 v77, v78, v79
    s_mov_b32 exec_hi, 0
    v_mov_b32 v68, v32
    v_mov_b32 v69, v33
    v_mov_b32 v70, v34
    v_mov_b32 v71, v35
    v_mov_b32 v76, v36
    v_mov_b32 v77, v37
    s_mov_b64 exec, -1
    s_call_b64 s[90:91], F_fact
    s_call_b64 s[90:91], F_out
    s_mov_b32 exec_hi, 0
    global_store_dwordx2 v74, v[64:65], s[40:41] sc1
    s_lshl_b64 exec, 1, s64
    v_mov_b32 v6, s71
    s_cmp_eq_u32 s92, 0
    s_cbranch_scc0 L_qd0
    global_store_dword v52, v6, s[40:41]
    s_branch L_qd1
L_qd0:
    global_store_dword v52, v6, s[40:41] sc1
L_qd1:
    s_mov_b64 exec, -1
    s_barrier
    s_barrier
    s_mov_b32 s43, 1
    s_mov_b32 exec_hi, 0
    s_mov_b32 s63, 0x4000
L_qw:
    global_load_dword v6, v52, s[40:41] sc1
    s_waitcnt vmcnt(0)
    v_xor_b32 v6, s71, v6
    v_cmp_ne_u32 vcc, 0, v6
    s_and_b64 exec, exec, vcc
    s_cbranch_execz L_qw_ok
    s_sub_u32 s63, s63, 1
    s_cbranch_scc1 L_qw_ok
    s_sleep 16
    s_branch L_qw
L_qw_ok:
    s_mov_b64 exec, -1
    v_xor_b32 v62, 512, v62
    s_mov_b32 s14, 10
L_w2:
    s_barrier
    s_sub_u32 s14, s14, 1
    s_cmp_eq_u32 s14, 0
    s_cbranch_scc0 L_w2
    s_setprio 3
    global_load_dwordx4 v[16:19], v53, s[40:41] offset:0 sc1
    global_load_dwordx4 v[20:23], v53, s[40:41] offset:128 sc1
    s_call_b64 s[90:91], F_wload
    s_call_b64 s[90:91], F_wtr
    s_call_b64 s[90:91], F_geto
    s_branch L_proj
.p2align 12
L_h3:
    s_lshr_b32 s7, s64, 2
    s_and_b32 s6, s64, 3
    s_lshl_b32 s10, s65, 2
    s_or_b32 s6, s6, s10
    s_lshl_b32 s68, s7, 5
    s_add_u32 s68, s68, s6
    s_lshl_b32 s10, s2, 12
    s_add_u32 s10, s10, 1048576
    v_add_u32 v52, s10, v56
    s_lshl_b32 s10, s7, 11
    s_lshl_b32 s11, s6, 5
    s_add_u32 s10, s10, s11
    v_bfe_u32 v5, v0, 2, 1
    v_lshl_add_u32 v5, v5, 10, s10
    v_and_b32 v6, 3, v0
    v_lshl_add_u32 v5, v6, 3, v5
    v_and_b32 v6, 1, v1
    v_lshl_add_u32 v5, v6, 2, v5
    v_lshl_add_u32 v49, v57, 1, v5
    v_lshlrev_b32 v48, 3, v57
    v_mov_b32 v16, 0
    v_mov_b32 v17, 1
    v_mov_b32 v18, 0
    v_mov_b32 v19, 0
    v_mov_b32 v17, s71
    v_lshlrev_b32 v23, 2, v0
    v_add_u32 v23, 5373952, v23
    s_lshr_b32 s66, s2, 3
    s_mov_b32 s67, 0
    s_mov_b32 s56, 0x11000000
    s_mov_b32 s57, 0x33222211
    s_mov_b32 s15, 4
    s_mov_b32 s14, 4
L_ck:
    s_barrier
    s_mov_b64 exec, 1
    s_bfe_u32 s10, s66, 0x30002
    s_add_u32 s10, s10, s67
    s_lshl_b32 s10, s10, 8
    s_and_b32 s11, s2, 7
    s_add_u32 s12, s10, 5373952
    s_load_dwordx8 s[16:23], s[40:41], s12 glc
    s_mov_b32 s12, 0
    s_waitcnt lgkmcnt(0)
    s_and_b32 s13, s66, 3
    s_cbranch_scc1 L_rk1
    s_lshl_b64 exec, 1, s11
    v_add_u32 v22, s10, v23
    global_store_dword v22, v17, s[40:41] sc1
L_rk1:
    s_cmp_eq_u32 s16, s71
    s_addc_u32 s12, s12, 0
    s_cmp_eq_u32 s17, s71
    s_addc_u32 s12, s12, 0
    s_cmp_eq_u32 s18, s71
    s_addc_u32 s12, s12, 0
    s_cmp_eq_u32 s19, s71
    s_addc_u32 s12, s12, 0
    s_cmp_eq_u32 s20, s71
    s_addc_u32 s12, s12, 0
    s_cmp_eq_u32 s21, s71
    s_addc_u32 s12, s12, 0
    s_cmp_eq_u32 s22, s71
    s_addc_u32 s12, s12, 0
    s_cmp_eq_u32 s23, s71
    s_addc_u32 s12, s12, 0
    s_lshl_b32 s12, s12, 1
    s_min_i32 s12, s12, 15
    s_lshl_b32 s11, s11, 1
    s_add_u32 s66, s66, s11
    s_add_u32 s66, s66, 1
    s_add_u32 s67, s67, 32
    s_mov_b64 exec, 1
    v_mov_b32 v18, s12
    v_add_u32 v16, 0x84, v16
    v_and_b32 v16, 0xff, v16
    s_mov_b32 s10, s12
    s_lshl_b32 s10, s10, 2
    s_lshr_b64 s[12:13], s[56:57], s10
    s_and_b32 s10, s12, 15
    v_mov_b32 v20, s10
    ds_write_b32 v19, v20 offset:1536
    s_mov_b64 exec, -1
    s_sub_u32 s14, s14, 1
    s_cmp_eq_u32 s14, 0
    s_cbranch_scc0 L_ck
    s_barrier
    s_mov_b32 exec_lo, 0xff00ff
    s_mov_b32 exec_hi, 0xff00ff
    v_mov_b32 v72, 0
    global_store_short v49, v72, s[36:37]
    s_waitcnt vmcnt(0)
    s_mov_b64 exec, -1
    ds_read_b64 v[72:73], v48 offset:1280
    ds_read_b64 v[76:77], v48 offset:1296
    s_mov_b32 s43, 0
    s_waitcnt lgkmcnt(0)
    s_call_b64 s[90:91], F_fact
    ds_write_b128 v56, v[72:75] offset:4096
    v_xor_b32 v62, 512, v62
    s_xor_b32 s70, s70, 512
    s_waitcnt vmcnt(0) lgkmcnt(0)
    s_mov_b32 s14, 7
L_cv:
    s_barrier
    s_mov_b64 exec, 1
    s_bfe_u32 s10, s66, 0x30002
    s_add_u32 s10, s10, s67
    s_lshl_b32 s10, s10, 8
    s_and_b32 s11, s2, 7
    s_add_u32 s12, s10, 5373952
    s_load_dwordx8 s[16:23], s[40:41], s12 glc
    s_mov_b32 s12, 0
    s_waitcnt lgkmcnt(0)
    s_and_b32 s13, s66, 3
    s_cbranch_scc1 L_rk2
    s_lshl_b64 exec, 1, s11
    v_add_u32 v22, s10, v23
    global_store_dword v22, v17, s[40:41] sc1
L_rk2:
    s_cmp_eq_u32 s16, s71
    s_addc_u32 s12, s12, 0
    s_cmp_eq_u32 s17, s71
    s_addc_u32 s12, s12, 0
    s_cmp_eq_u32 s18, s71
    s_addc_u32 s12, s12, 0
    s_cmp_eq_u32 s19, s71
    s_addc_u32 s12, s12, 0
    s_cmp_eq_u32 s20, s71
    s_addc_u32 s12, s12, 0
    s_cmp_eq_u32 s21, s71
    s_addc_u32 s12, s12, 0
    s_cmp_eq_u32 s22, s71
    s_addc_u32 s12, s12, 0
    s_cmp_eq_u32 s23, s71
    s_addc_u32 s12, s12, 0
    s_lshl_b32 s12, s12, 1
    s_min_i32 s12, s12, 15
    s_lshl_b32 s11, s11, 1
    s_add_u32 s66, s66, s11
    s_add_u32 s66, s66, 1
    s_add_u32 s67, s67, 32
    s_mov_b64 exec, 1
    v_mov_b32 v18, s12
    v_add_u32 v16, 0x84, v16
    v_and_b32 v16, 0xff, v16
    s_mov_b32 s10, s12
    s_lshl_b32 s10, s10, 2
    s_lshr_b64 s[12:13], s[56:57], s10
    s_and_b32 s10, s12, 15
    v_mov_b32 v20, s10
    ds_write_b32 v19, v20 offset:1536
    s_mov_b64 exec, -1
    s_sub_u32 s14, s14, 1
    s_cmp_eq_u32 s14, 0
    s_cbranch_scc0 L_cv
    s_setprio 3
    s_barrier
    s_call_b64 s[90:91], F_wload
    s_barrier
    s_call_b64 s[90:91], F_wtr
    s_mov_b32 s63, 0x3fff
    s_call_b64 s[90:91], L_po_f
L_proj:
    s_call_b64 s[90:91], F_mm
    s_mov_b32 s63, 0x4000
L_pub:
    s_cmp_eq_u32 s92, 0
    s_cbranch_scc0 L_pub0
    v_bfi_b32 v96, s72, v62, v32
    v_bfi_b32 v97, s72, v62, v36
    v_bfi_b32 v98, s72, v62, v40
    v_bfi_b32 v99, s72, v62, v44
    global_store_dwordx4 v58, v[96:99], s[40:41]
    v_bfi_b32 v100, s72, v62, v33
    v_bfi_b32 v101, s72, v62, v37
    v_bfi_b32 v102, s72, v62, v41
    v_bfi_b32 v103, s72, v62, v45
    global_store_dwordx4 v59, v[100:103], s[40:41]
    v_bfi_b32 v104, s72, v62, v34
    v_bfi_b32 v105, s72, v62, v38
    v_bfi_b32 v106, s72, v62, v42
    v_bfi_b32 v107, s72, v62, v46
    global_store_dwordx4 v60, v[104:107], s[40:41]
    v_bfi_b32 v108, s72, v62, v35
    v_bfi_b32 v109, s72, v62, v39
    v_bfi_b32 v110, s72, v62, v43
    v_bfi_b32 v111, s72, v62, v47
    global_store_dwordx4 v61, v[108:111], s[40:41]
L_pub1:
    s_cmp_eq_u32 s43, 1
    s_cbranch_scc1 L_end
    s_mov_b64 exec, -1
    global_load_dwordx4 v[112:115], v52, s[40:41] offset:0 sc1
    global_load_dwordx4 v[116:119], v52, s[40:41] offset:1024 sc1
    global_load_dwordx4 v[120:123], v52, s[40:41] offset:2048 sc1
    global_load_dwordx4 v[124:127], v52, s[40:41] offset:3072 sc1
    s_sleep 1
    global_load_dwordx4 v[112:115], v52, s[40:41] offset:0 sc1
    global_load_dwordx4 v[116:119], v52, s[40:41] offset:1024 sc1
    global_load_dwordx4 v[120:123], v52, s[40:41] offset:2048 sc1
    global_load_dwordx4 v[124:127], v52, s[40:41] offset:3072 sc1
    s_sleep 1
L_pf:
    global_load_dwordx4 v[112:115], v52, s[40:41] offset:0 sc1
    global_load_dwordx4 v[116:119], v52, s[40:41] offset:1024 sc1
    global_load_dwordx4 v[120:123], v52, s[40:41] offset:2048 sc1
    global_load_dwordx4 v[124:127], v52, s[40:41] offset:3072 sc1
L_pf1:
    s_waitcnt vmcnt(8)
    v_xor_b32 v64, s70, v112
    v_xor_b32 v65, s70, v113
    v_xor_b32 v66, s70, v114
    v_xor_b32 v67, s70, v115
    v_xor_b32 v68, s70, v116
    v_xor_b32 v69, s70, v117
    v_xor_b32 v70, s70, v118
    v_xor_b32 v71, s70, v119
    v_xor_b32 v72, s70, v120
    v_xor_b32 v73, s70, v121
    v_xor_b32 v74, s70, v122
    v_xor_b32 v75, s70, v123
    v_xor_b32 v76, s70, v124
    v_xor_b32 v77, s70, v125
    v_xor_b32 v78, s70, v126
    v_xor_b32 v79, s70, v127
    v_or_b32 v6, v64, v65
    v_or3_b32 v6, v6, v66, v67
    v_or3_b32 v6, v6, v68, v69
    v_or3_b32 v6, v6, v70, v71
    v_or3_b32 v6, v6, v72, v73
    v_or3_b32 v6, v6, v74, v75
    v_or3_b32 v6, v6, v76, v77
    v_or3_b32 v6, v6, v78, v79
    v_and_b32 v6, s72, v6
    v_cmp_ne_u32 vcc, 0, v6
    s_and_b64 exec, exec, vcc
    s_cbranch_execz L_pf_ok
    s_sub_u32 s63, s63, 1
    s_cbranch_scc1 L_pf_ok
    s_branch L_pf
L_pf_ok:
    s_mov_b64 exec, -1
    v_add_f32 v64, v64, v68
    v_add_f32 v65, v65, v69
    v_add_f32 v66, v66, v70
    v_add_f32 v67, v67, v71
    v_add_f32 v72, v72, v76
    v_add_f32 v73, v73, v77
    v_add_f32 v74, v74, v78
    v_add_f32 v75, v75, v79
    v_add_f32 v64, v64, v72
    v_add_f32 v65, v65, v73
    v_add_f32 v66, v66, v74
    v_add_f32 v67, v67, v75
    v_permlane32_swap_b32 v64, v65
    s_nop 0
    v_permlane32_swap_b32 v66, v67
    v_add_f32 v64, v64, v65
    v_add_f32 v66, v66, v67
    s_nop 1
    v_permlane16_swap_b32 v64, v66
    v_add_f32 v64, v64, v66
    s_nop 1
    v_add_f32_dpp v64, v64, v64 row_ror:8 row_mask:0xf bank_mask:0xf
    s_mov_b32 exec_lo, 0xff00ff
    s_mov_b32 exec_hi, 0xff00ff
    v_cvt_pk_bf16_f32 v64, v64, v64
    global_store_short v49, v64, s[36:37]
    s_cmp_eq_u32 s2, 0
    s_cbranch_scc0 L_fini
    s_mov_b64 exec, 1
    v_mov_b32 v5, 0
    v_mov_b32 v6, s71
    global_store_dword v5, v6, s[40:41]
L_fini:
L_end:
    s_endpgm
L_pub0:
    v_bfi_b32 v96, s72, v62, v32
    v_bfi_b32 v97, s72, v62, v36
    v_bfi_b32 v98, s72, v62, v40
    v_bfi_b32 v99, s72, v62, v44
    v_bfi_b32 v100, s72, v62, v33
    v_bfi_b32 v101, s72, v62, v37
    v_bfi_b32 v102, s72, v62, v41
    v_bfi_b32 v103, s72, v62, v45
    v_bfi_b32 v104, s72, v62, v34
    v_bfi_b32 v105, s72, v62, v38
    v_bfi_b32 v106, s72, v62, v42
    v_bfi_b32 v107, s72, v62, v46
    v_bfi_b32 v108, s72, v62, v35
    v_bfi_b32 v109, s72, v62, v39
    v_bfi_b32 v110, s72, v62, v43
    v_bfi_b32 v111, s72, v62, v47
    global_store_dwordx4 v58, v[96:99], s[40:41] sc1
    global_store_dwordx4 v59, v[100:103], s[40:41] sc1
    global_store_dwordx4 v60, v[104:107], s[40:41] sc1
    global_store_dwordx4 v61, v[108:111], s[40:41] sc1
    s_branch L_pub1
F_getq:
    s_mov_b32 s63, 0x4000
L_pq:
    global_load_dwordx4 v[80:83], v50, s[40:41] offset:0 sc1
    s_waitcnt vmcnt(0)
    v_xor_b32 v80, s70, v80
    v_xor_b32 v81, s70, v81
    v_xor_b32 v82, s70, v82
    v_xor_b32 v83, s70, v83
    v_or_b32 v6, v80, v81
    v_or3_b32 v6, v6, v82, v83
    v_and_b32 v6, s72, v6
    v_cmp_ne_u32 vcc, 0, v6
    s_and_b64 exec, exec, vcc
    s_cbranch_execz L_pq_ok
    s_sub_u32 s63, s63, 1
    s_cbranch_scc1 L_pq_ok
    s_sleep 4
    s_branch L_pq
L_pq_ok:
    s_mov_b64 exec, -1
    v_mov_b32 v84, v80
    v_mov_b32 v85, v81
    v_mov_b32 v86, v82
    v_mov_b32 v87, v83
    v_permlane32_swap_b32 v84, v80
    v_permlane32_swap_b32 v85, v81
    v_permlane32_swap_b32 v86, v82
    v_permlane32_swap_b32 v87, v83
    v_add_f32 v80, v80, v84
    v_add_f32 v81, v81, v85
    v_add_f32 v82, v82, v86
    v_add_f32 v83, v83, v87
    v_cvt_pk_bf16_f32 v80, v80, v81
    v_cvt_pk_bf16_f32 v81, v82, v83
    s_mov_b32 exec_hi, 0
    ds_write_b64 v51, v[80:81]
    s_mov_b64 exec, -1
    s_setpc_b64 s[90:91]
F_wtr:
    s_waitcnt vmcnt(24)
    v_perm_b32 v112, v130, v128, s73
    v_perm_b32 v113, v134, v132, s73
    v_perm_b32 v114, v138, v136, s73
    v_perm_b32 v115, v142, v140, s73
    v_perm_b32 v116, v130, v128, s74
    v_perm_b32 v117, v134, v132, s74
    v_perm_b32 v118, v138, v136, s74
    v_perm_b32 v119, v142, v140, s74
    v_perm_b32 v120, v131, v129, s73
    v_perm_b32 v121, v135, v133, s73
    v_perm_b32 v122, v139, v137, s73
    v_perm_b32 v123, v143, v141, s73
    v_perm_b32 v124, v131, v129, s74
    v_perm_b32 v125, v135, v133, s74
    v_perm_b32 v126, v139, v137, s74
    v_perm_b32 v127, v143, v141, s74
    s_waitcnt vmcnt(16)
    v_perm_b32 v128, v146, v144, s73
    v_perm_b32 v129, v150, v148, s73
    v_perm_b32 v130, v154, v152, s73
    v_perm_b32 v131, v158, v156, s73
    v_perm_b32 v132, v146, v144, s74
    v_perm_b32 v133, v150, v148, s74
    v_perm_b32 v134, v154, v152, s74
    v_perm_b32 v135, v158, v156, s74
    v_perm_b32 v136, v147, v145, s73
    v_perm_b32 v137, v151, v149, s73
    v_perm_b32 v138, v155, v153, s73
    v_perm_b32 v139, v159, v157, s73
    v_perm_b32 v140, v147, v145, s74
    v_perm_b32 v141, v151, v149, s74
    v_perm_b32 v142, v155, v153, s74
    v_perm_b32 v143, v159, v157, s74
    s_waitcnt vmcnt(8)
    v_perm_b32 v144, v162, v160, s73
    v_perm_b32 v145, v166, v164, s73
    v_perm_b32 v146, v170, v168, s73
    v_perm_b32 v147, v174, v172, s73
    v_perm_b32 v148, v162, v160, s74
    v_perm_b32 v149, v166, v164, s74
    v_perm_b32 v150, v170, v168, s74
    v_perm_b32 v151, v174, v172, s74
    v_perm_b32 v152, v163, v161, s73
    v_perm_b32 v153, v167, v165, s73
    v_perm_b32 v154, v171, v169, s73
    v_perm_b32 v155, v175, v173, s73
    v_perm_b32 v156, v163, v161, s74
    v_perm_b32 v157, v167, v165, s74
    v_perm_b32 v158, v171, v169, s74
    v_perm_b32 v159, v175, v173, s74
    s_waitcnt vmcnt(0)
    v_perm_b32 v160, v178, v176, s73
    v_perm_b32 v161, v182, v180, s73
    v_perm_b32 v162, v186, v184, s73
    v_perm_b32 v163, v190, v188, s73
    v_perm_b32 v164, v178, v176, s74
    v_perm_b32 v165, v182, v180, s74
    v_perm_b32 v166, v186, v184, s74
    v_perm_b32 v167, v190, v188, s74
    v_perm_b32 v168, v179, v177, s73
    v_perm_b32 v169, v183, v181, s73
    v_perm_b32 v170, v187, v185, s73
    v_perm_b32 v171, v191, v189, s73
    v_perm_b32 v172, v179, v177, s74
    v_perm_b32 v173, v183, v181, s74
    v_perm_b32 v174, v187, v185, s74
    v_perm_b32 v175, v191, v189, s74
    s_setpc_b64 s[90:91]
F_fact:
    v_max_f32 v78, v72, v76
    v_mov_b32 v79, v78
    s_nop 1
    v_permlane32_swap_b32 v79, v78
    v_max_f32 v78, v78, v79
    v_sub_f32 v72, v72, v78
    v_sub_f32 v76, v76, v78
    v_mul_f32 v72, s9, v72
    v_mul_f32 v76, s9, v76
    v_exp_f32 v72, v72
    v_exp_f32 v76, v76
    v_mul_f32 v73, v72, v73
    v_fmac_f32 v73, v76, v77
    v_mov_b32 v79, v73
    s_nop 1
    v_permlane32_swap_b32 v79, v73
    v_add_f32 v73, v73, v79
    v_rcp_f32 v73, v73
    v_mov_b32 v74, v54
    v_mov_b32 v75, v62
    v_mul_f32 v72, v72, v73
    v_mul_f32 v73, v76, v73
    s_setpc_b64 s[90:91]
F_out:
    v_mul_f32 v64, v72, v64
    v_mul_f32 v65, v72, v65
    v_mul_f32 v66, v72, v66
    v_mul_f32 v67, v72, v67
    v_fmac_f32 v64, v73, v68
    v_fmac_f32 v65, v73, v69
    v_fmac_f32 v66, v73, v70
    v_fmac_f32 v67, v73, v71
    v_mov_b32 v68, v64
    v_mov_b32 v69, v65
    v_mov_b32 v70, v66
    v_mov_b32 v71, v67
    v_permlane32_swap_b32 v68, v64
    v_permlane32_swap_b32 v69, v65
    v_permlane32_swap_b32 v70, v66
    v_permlane32_swap_b32 v71, v67
    v_add_f32 v64, v64, v68
    v_add_f32 v65, v65, v69
    v_add_f32 v66, v66, v70
    v_add_f32 v67, v67, v71
    v_cvt_pk_bf16_f32 v64, v64, v65
    v_cvt_pk_bf16_f32 v65, v66, v67
    v_min_u32 v64, -2, v64
    v_min_u32 v65, -2, v65
    s_setpc_b64 s[90:91]
F_geto:
    s_mov_b32 s63, 0x4000
    s_waitcnt vmcnt(0)
    s_branch L_po_c
L_po_f:
    global_load_dwordx4 v[16:19], v53, s[40:41] offset:0 sc1
    global_load_dwordx4 v[20:23], v53, s[40:41] offset:128 sc1
    s_sleep 6
L_po:
    global_load_dwordx4 v[16:19], v53, s[40:41] offset:0 sc1
    global_load_dwordx4 v[20:23], v53, s[40:41] offset:128 sc1
    s_waitcnt vmcnt(2)
L_po_c:
    v_max3_u32 v6, v16, v17, v18
    v_max3_u32 v7, v19, v20, v21
    v_max3_u32 v6, v6, v22, v23
    v_max_u32 v6, v6, v7
    v_cmp_eq_u32 vcc, -1, v6
    s_and_b64 exec, exec, vcc
    s_cbranch_execz L_po_ok
    s_bitcmp1_b32 s63, 14
    s_cmov_b32 s63, 0x3fff
    s_cbranch_scc1 L_po_f
    s_sub_u32 s63, s63, 1
    s_cbranch_scc1 L_po_ok
    s_cmp_eq_u32 s43, 0
    s_cbranch_scc1 L_po
    s_sleep 16
    s_branch L_po
L_po_ok:
    s_mov_b64 exec, -1
    s_setpc_b64 s[90:91]
F_mm:
    v_mfma_f32_16x16x32_bf16 v[32:35], v[16:19], v[112:115], 0
    v_mov_b32_dpp v24, v16 row_ror:8 row_mask:0xf bank_mask:0xf
    v_mfma_f32_16x16x32_bf16 v[36:39], v[16:19], v[116:119], 0
    v_mov_b32_dpp v25, v17 row_ror:8 row_mask:0xf bank_mask:0xf
    v_mfma_f32_16x16x32_bf16 v[40:43], v[16:19], v[120:123], 0
    v_mov_b32_dpp v26, v18 row_ror:8 row_mask:0xf bank_mask:0xf
    v_mfma_f32_16x16x32_bf16 v[44:47], v[16:19], v[124:127], 0
    v_mov_b32_dpp v27, v19 row_ror:8 row_mask:0xf bank_mask:0xf
    v_mfma_f32_16x16x32_bf16 v[32:35], v[20:23], v[128:131], v[32:35]
    v_mov_b32_dpp v28, v20 row_ror:8 row_mask:0xf bank_mask:0xf
    v_mfma_f32_16x16x32_bf16 v[36:39], v[20:23], v[132:135], v[36:39]
    v_mov_b32_dpp v29, v21 row_ror:8 row_mask:0xf bank_mask:0xf
    v_mfma_f32_16x16x32_bf16 v[40:43], v[20:23], v[136:139], v[40:43]
    v_mov_b32_dpp v30, v22 row_ror:8 row_mask:0xf bank_mask:0xf
    v_mfma_f32_16x16x32_bf16 v[44:47], v[20:23], v[140:143], v[44:47]
    v_mov_b32_dpp v31, v23 row_ror:8 row_mask:0xf bank_mask:0xf
    v_mfma_f32_16x16x32_bf16 v[32:35], v[24:27], v[144:147], v[32:35]
    v_mfma_f32_16x16x32_bf16 v[36:39], v[24:27], v[148:151], v[36:39]
    v_mfma_f32_16x16x32_bf16 v[40:43], v[24:27], v[152:155], v[40:43]
    v_mfma_f32_16x16x32_bf16 v[44:47], v[24:27], v[156:159], v[44:47]
    v_mfma_f32_16x16x32_bf16 v[32:35], v[28:31], v[160:163], v[32:35]
    v_mfma_f32_16x16x32_bf16 v[36:39], v[28:31], v[164:167], v[36:39]
    v_mfma_f32_16x16x32_bf16 v[40:43], v[28:31], v[168:171], v[40:43]
    v_mfma_f32_16x16x32_bf16 v[44:47], v[28:31], v[172:175], v[44:47]
    s_nop 3
    s_mov_b32 exec_hi, 0
L_last:
    s_setpc_b64 s[90:91]
.section .rodata,"a"
.p2align 6
.amdhsa_kernel concat_heads__sliding_block_cached__mha_block_cached__decode_kernel
  .amdhsa_next_free_vgpr 192
  .amdhsa_next_free_sgpr 96
  .amdhsa_accum_offset 192
  .amdhsa_group_segment_fixed_size 0
  .amdhsa_kernarg_size 104
  .amdhsa_user_sgpr_count 2
  .amdhsa_user_sgpr_kernarg_segment_ptr 1
  .amdhsa_system_sgpr_workgroup_id_x 1
  .amdhsa_float_denorm_mode_32 3
.end_amdhsa_kernel
```
